```python
import torch

def _softmax(x, axis=-1):
    return torch.softmax(x, dim=axis)
def _gelu(x):
    return torch.nn.functional.gelu(x, approximate="tanh")
def _silu(x):
    return torch.nn.functional.silu(x)
def _sigmoid(x):
    return torch.sigmoid(x)
def _layernorm(x, axis=-1, eps=1e-5):
    m = x.mean(dim=axis, keepdim=True)
    v = x.var(dim=axis, keepdim=True, unbiased=False)
    return (x - m) / torch.sqrt(v + eps)
def _scatter_add(tgt, idx, src, axis=0):
    return tgt.clone().index_add_(axis, idx, src)
def _segment_sum(src, seg, n):
    out = torch.zeros((n,) + src.shape[1:], dtype=src.dtype)
    return out.index_add_(0, seg, src)
def _pad(x, pw):
    flat = tuple(v for pair in reversed(pw) for v in pair)
    return torch.nn.functional.pad(x, flat)

kernel_name = 'sequential_preLN__spectral_gfnet__moe_arch_mod__prompt'

def setup_inputs():

    _w = (lambda a: (lambda t: t.to(torch.bfloat16) if t.is_floating_point() else t)(torch.as_tensor(a)))
    def _A_setup():
        B, S, D = 1, 2048, 576
        Df = D // 2 + 1
        return {
            "x": _w((lambda *s: torch.randn(*s, dtype=torch.bfloat16) * 0.05)(B, S, D)),
            "w_r": _w((lambda *s: torch.randn(*s, dtype=torch.bfloat16) * 0.4)(S, Df) * 0.02),
            "w_i": _w((lambda *s: torch.randn(*s, dtype=torch.bfloat16) * 0.4)(S, Df) * 0.02),
        }
    _A_in = _A_setup()

    def _B_setup():
        B, S, D, F, C = 1, 2048, 576, 4608, 2
        return {
            "x": _w((lambda *s: torch.randn(*s, dtype=torch.bfloat16) * 0.05)(B, S, D)),
            "w_r": _w((lambda *s: torch.randn(*s, dtype=torch.bfloat16) * 0.05)(D)),
            "w_gate": _w((lambda *s: torch.randn(*s, dtype=torch.bfloat16) * 0.05)(D, F)),
            "w_up": _w((lambda *s: torch.randn(*s, dtype=torch.bfloat16) * 0.05)(D, F)),
            "w_down": _w((lambda *s: torch.randn(*s, dtype=torch.bfloat16) * 0.05)(F, D)),
        }
    _B_in = _B_setup()

    return {
        "A_x": _A_in["x"],
        "A_w_r": _A_in["w_r"],
        "A_w_i": _A_in["w_i"],
        "B_x": _B_in["x"],
        "B_w_r": _B_in["w_r"],
        "B_w_gate": _B_in["w_gate"],
        "B_w_up": _B_in["w_up"],
        "B_w_down": _B_in["w_down"],
    }

def reference(A_x, A_w_r, A_w_i, B_x, B_w_r, B_w_gate, B_w_up, B_w_down):
    def _A_ref(x, w_r, w_i):
        B, S, D = x.shape
        X = (lambda x, axes=(-2,-1): torch.fft.rfft2(x.float(), dim=axes))(x, axes=(-2, -1))
        W = w_r + 1j * w_i
        X = X * W
        y = (lambda x, s, axes=(-2,-1): torch.fft.irfft2(x, s=s, dim=axes).to(torch.bfloat16))(X, (S, D), axes=(-2, -1))
        return y

    def _B_ref(x, w_r, w_gate, w_up, w_down):
        B, S, D = x.shape
        C = 2
        r = x @ w_r
        idx = torch.argsort(-r, axis=-1)[:, :C]
        idx_e = (lambda x, n, axis: torch.repeat_interleave(x, n, dim=axis))(idx.reshape(B, C, 1), D, axis=2)
        x_sel = (lambda x, i, axis: torch.take_along_dim(x, i, dim=axis))(x, idx_e, axis=1)
        g = _silu(x_sel @ w_gate)
        u = x_sel @ w_up
        y = (g * u) @ w_down
        r_sel = _sigmoid((lambda x, i, axis: torch.take_along_dim(x, i, dim=axis))(r, idx, axis=1))
        y = y * r_sel.reshape(B, C, 1)
        b_off = (torch.arange(B) * S).reshape(B, 1)
        flat_idx = (idx + b_off).reshape(B * C)
        zero = (x * 0.0).reshape(B * S, D)
        upd = _scatter_add(zero, flat_idx, y.reshape(B * C, D), axis=0)
        return x + upd.reshape(B, S, D)

    x = A_x
    h = x + _A_ref(_layernorm(x, axis=-1), A_w_r, A_w_i)
    h2 = h + _B_ref(_layernorm(h, axis=-1), B_w_r, B_w_gate, B_w_up, B_w_down)
    return h2
```

```asm
; @launch kernel=fa_kernel grid=(552,1,1) block=(256,1,1) lds=13824
; @launch kernel=fb_kernel grid=(440,1,1) block=(256,1,1) lds=8704
; @launch kernel=fc_kernel grid=(400,1,1) block=(256,1,1) lds=41472
.amdgcn_target "amdgcn-amd-amdhsa--gfx950"
.text
.globl fa_kernel
.p2align 8
.type fa_kernel,@function
fa_kernel:
    s_cmp_ge_u32 s2, 401
    s_cbranch_scc1 K1_PF
    s_load_dwordx4 s[4:7], s[0:1], 0
    s_load_dwordx2 s[8:9], s[0:1], 16
    s_load_dwordx2 s[10:11], s[0:1], 80
    s_cmp_ge_u32 s2, 256
    s_cbranch_scc1 K1_TR
    s_and_b32 s3, s2, 7
    s_lshl_b32 s3, s3, 5
    s_lshr_b32 s12, s2, 3
    s_add_u32 s3, s3, s12
    v_lshrrev_b32 v1, 5, v0
    v_and_b32 v2, 31, v0
    s_and_b32 s12, s3, 7
    s_lshl_b32 s12, s12, 3
    v_add_u32 v3, s12, v1
    v_lshlrev_b32 v3, 5, v3
    s_lshr_b32 s12, s3, 3
    v_add_u32 v3, s12, v3
    v_mul_u32_u24 v3, 1152, v3
    v_lshl_add_u32 v3, v2, 1, v3
    s_waitcnt lgkmcnt(0)
    s_mov_b32 s16, s4
    s_mov_b32 s17, s5
    s_mov_b32 s18, 0x240000
    s_mov_b32 s19, 0x20000
    s_mov_b32 s20, s10
    s_mov_b32 s21, s11
    s_mov_b32 s22, 0x242000
    s_mov_b32 s23, 0x20000
    buffer_load_ushort v10, v3, s[16:19], 0 offen offset:0
    buffer_load_ushort v11, v3, s[16:19], 0 offen offset:64
    buffer_load_ushort v12, v3, s[16:19], 0 offen offset:128
    buffer_load_ushort v13, v3, s[16:19], 0 offen offset:192
    buffer_load_ushort v14, v3, s[16:19], 0 offen offset:256
    buffer_load_ushort v15, v3, s[16:19], 0 offen offset:320
    buffer_load_ushort v16, v3, s[16:19], 0 offen offset:384
    buffer_load_ushort v17, v3, s[16:19], 0 offen offset:448
    buffer_load_ushort v18, v3, s[16:19], 0 offen offset:512
    buffer_load_ushort v19, v3, s[16:19], 0 offen offset:576
    buffer_load_ushort v20, v3, s[16:19], 0 offen offset:640
    buffer_load_ushort v21, v3, s[16:19], 0 offen offset:704
    buffer_load_ushort v22, v3, s[16:19], 0 offen offset:768
    buffer_load_ushort v23, v3, s[16:19], 0 offen offset:832
    buffer_load_ushort v24, v3, s[16:19], 0 offen offset:896
    buffer_load_ushort v25, v3, s[16:19], 0 offen offset:960
    buffer_load_ushort v26, v3, s[16:19], 0 offen offset:1024
    buffer_load_ushort v27, v3, s[16:19], 0 offen offset:1088
    v_cvt_f32_u32 v4, v2
    v_mul_f32 v5, 0x3ae38e39, v4
    v_cos_f32 v30, v5
    v_sin_f32 v31, v5
    s_nop 0
    v_mul_f32 v30, 0x3e715bef, v30
    v_mul_f32 v31, 0x3e715bef, v31
    v_mul_f32 v5, 0x3b638e39, v4
    v_cos_f32 v32, v5
    v_sin_f32 v33, v5
    s_nop 0
    v_mul_f32 v32, 0x3e715bef, v32
    v_mul_f32 v33, 0x3e715bef, v33
    v_mul_f32 v5, 0x3baaaaab, v4
    v_cos_f32 v34, v5
    v_sin_f32 v35, v5
    s_nop 0
    v_mul_f32 v34, 0x3e715bef, v34
    v_mul_f32 v35, 0x3e715bef, v35
    v_mul_f32 v5, 0x3be38e39, v4
    v_cos_f32 v36, v5
    v_sin_f32 v37, v5
    s_nop 0
    v_mul_f32 v36, 0x3e715bef, v36
    v_mul_f32 v37, 0x3e715bef, v37
    v_mul_f32 v5, 0x3c0e38e4, v4
    v_cos_f32 v38, v5
    v_sin_f32 v39, v5
    s_nop 0
    v_mul_f32 v38, 0x3e715bef, v38
    v_mul_f32 v39, 0x3e715bef, v39
    v_mul_f32 v5, 0x3c2aaaab, v4
    v_cos_f32 v40, v5
    v_sin_f32 v41, v5
    s_nop 0
    v_mul_f32 v40, 0x3e715bef, v40
    v_mul_f32 v41, 0x3e715bef, v41
    v_mul_f32 v5, 0x3c471c72, v4
    v_cos_f32 v42, v5
    v_sin_f32 v43, v5
    s_nop 0
    v_mul_f32 v42, 0x3e715bef, v42
    v_mul_f32 v43, 0x3e715bef, v43
    v_mul_f32 v5, 0x3c638e39, v4
    v_cos_f32 v44, v5
    v_sin_f32 v45, v5
    s_nop 0
    v_mul_f32 v44, 0x3e715bef, v44
    v_mul_f32 v45, 0x3e715bef, v45
    v_mul_f32 v5, 0x3c800000, v4
    v_cos_f32 v46, v5
    v_sin_f32 v47, v5
    s_nop 0
    v_mul_f32 v46, 0x3e715bef, v46
    v_mul_f32 v47, 0x3e715bef, v47
    v_lshrrev_b32 v6, 6, v0
    v_and_b32 v7, 63, v0
    s_nop 0
    v_readfirstlane_b32 s13, v6
    v_and_b32 v8, 15, v7
    v_lshrrev_b32 v9, 4, v7
    s_and_b32 s14, s13, 1
    s_lshl_b32 s15, s14, 4
    v_add_u32 v64, s15, v8
    v_cvt_f32_u32 v65, v64
    v_mul_f32 v65, 0x3d000000, v65
    v_lshlrev_b32 v66, 2, v9
    v_cvt_f32_u32 v66, v66
    s_mul_i32 s15, s14, 0x80008000
    v_and_b32 v67, 1, v8
    v_mul_u32_u24 v67, 0x8000, v67
    v_lshl_or_b32 v67, v67, 16, v67
    v_add_f32 v5, 0.0, v66
    v_mul_f32 v5, v5, v65
    v_cos_f32 v68, v5
    v_sin_f32 v69, v5
    s_nop 0
    v_mul_f32 v68, 0x3e3504f3, v68
    v_mul_f32 v69, 0x3e3504f3, v69
    v_cvt_pk_f16_f32 v48, v68, v69
    v_cvt_pk_f16_f32 v56, -v69, v68
    v_xor_b32 v56, s15, v56
    v_xor_b32 v52, v67, v48
    v_xor_b32 v60, v67, v56
    v_add_f32 v5, 1.0, v66
    v_mul_f32 v5, v5, v65
    v_cos_f32 v68, v5
    v_sin_f32 v69, v5
    s_nop 0
    v_mul_f32 v68, 0x3e3504f3, v68
    v_mul_f32 v69, 0x3e3504f3, v69
    v_cvt_pk_f16_f32 v49, v68, v69
    v_cvt_pk_f16_f32 v57, -v69, v68
    v_xor_b32 v57, s15, v57
    v_xor_b32 v53, v67, v49
    v_xor_b32 v61, v67, v57
    v_add_f32 v5, 2.0, v66
    v_mul_f32 v5, v5, v65
    v_cos_f32 v68, v5
    v_sin_f32 v69, v5
    s_nop 0
    v_mul_f32 v68, 0x3e3504f3, v68
    v_mul_f32 v69, 0x3e3504f3, v69
    v_cvt_pk_f16_f32 v50, v68, v69
    v_cvt_pk_f16_f32 v58, -v69, v68
    v_xor_b32 v58, s15, v58
    v_xor_b32 v54, v67, v50
    v_xor_b32 v62, v67, v58
    v_add_f32 v5, 3.0, v66
    v_mul_f32 v5, v5, v65
    v_cos_f32 v68, v5
    v_sin_f32 v69, v5
    s_nop 0
    v_mul_f32 v68, 0x3e3504f3, v68
    v_mul_f32 v69, 0x3e3504f3, v69
    v_cvt_pk_f16_f32 v51, v68, v69
    v_cvt_pk_f16_f32 v59, -v69, v68
    v_xor_b32 v59, s15, v59
    v_xor_b32 v55, v67, v51
    v_xor_b32 v63, v67, v59
    s_waitcnt vmcnt(0)
    v_lshlrev_b32 v10, 16, v10
    v_lshlrev_b32 v11, 16, v11
    v_lshlrev_b32 v12, 16, v12
    v_lshlrev_b32 v13, 16, v13
    v_lshlrev_b32 v14, 16, v14
    v_lshlrev_b32 v15, 16, v15
    v_lshlrev_b32 v16, 16, v16
    v_lshlrev_b32 v17, 16, v17
    v_lshlrev_b32 v18, 16, v18
    v_lshlrev_b32 v19, 16, v19
    v_lshlrev_b32 v20, 16, v20
    v_lshlrev_b32 v21, 16, v21
    v_lshlrev_b32 v22, 16, v22
    v_lshlrev_b32 v23, 16, v23
    v_lshlrev_b32 v24, 16, v24
    v_lshlrev_b32 v25, 16, v25
    v_lshlrev_b32 v26, 16, v26
    v_lshlrev_b32 v27, 16, v27
    v_add_f32 v70, v10, v11
    v_add_f32 v70, v70, v12
    v_add_f32 v70, v70, v13
    v_add_f32 v70, v70, v14
    v_add_f32 v70, v70, v15
    v_add_f32 v70, v70, v16
    v_add_f32 v70, v70, v17
    v_add_f32 v70, v70, v18
    v_add_f32 v70, v70, v19
    v_add_f32 v70, v70, v20
    v_add_f32 v70, v70, v21
    v_add_f32 v70, v70, v22
    v_add_f32 v70, v70, v23
    v_add_f32 v70, v70, v24
    v_add_f32 v70, v70, v25
    v_add_f32 v70, v70, v26
    v_add_f32 v70, v70, v27
    s_nop 1
    v_add_f32_dpp v70, v70, v70 quad_perm:[1,0,3,2] row_mask:0xf bank_mask:0xf
    s_nop 1
    v_add_f32_dpp v70, v70, v70 quad_perm:[2,3,0,1] row_mask:0xf bank_mask:0xf
    s_nop 1
    v_add_f32_dpp v70, v70, v70 row_half_mirror row_mask:0xf bank_mask:0xf
    s_nop 1
    v_add_f32_dpp v70, v70, v70 row_mirror row_mask:0xf bank_mask:0xf
    ds_swizzle_b32 v72, v70 offset:0x401F
    s_waitcnt lgkmcnt(0)
    v_add_f32 v70, v70, v72
    v_mul_f32 v70, 0x3ae38e39, v70
    v_sub_f32 v73, v10, v70
    v_mul_f32 v71, v73, v73
    v_sub_f32 v73, v11, v70
    v_fmac_f32 v71, v73, v73
    v_sub_f32 v73, v12, v70
    v_fmac_f32 v71, v73, v73
    v_sub_f32 v73, v13, v70
    v_fmac_f32 v71, v73, v73
    v_sub_f32 v73, v14, v70
    v_fmac_f32 v71, v73, v73
    v_sub_f32 v73, v15, v70
    v_fmac_f32 v71, v73, v73
    v_sub_f32 v73, v16, v70
    v_fmac_f32 v71, v73, v73
    v_sub_f32 v73, v17, v70
    v_fmac_f32 v71, v73, v73
    v_sub_f32 v73, v18, v70
    v_fmac_f32 v71, v73, v73
    v_sub_f32 v73, v19, v70
    v_fmac_f32 v71, v73, v73
    v_sub_f32 v73, v20, v70
    v_fmac_f32 v71, v73, v73
    v_sub_f32 v73, v21, v70
    v_fmac_f32 v71, v73, v73
    v_sub_f32 v73, v22, v70
    v_fmac_f32 v71, v73, v73
    v_sub_f32 v73, v23, v70
    v_fmac_f32 v71, v73, v73
    v_sub_f32 v73, v24, v70
    v_fmac_f32 v71, v73, v73
    v_sub_f32 v73, v25, v70
    v_fmac_f32 v71, v73, v73
    v_sub_f32 v73, v26, v70
    v_fmac_f32 v71, v73, v73
    v_sub_f32 v73, v27, v70
    v_fmac_f32 v71, v73, v73
    s_nop 1
    v_add_f32_dpp v71, v71, v71 quad_perm:[1,0,3,2] row_mask:0xf bank_mask:0xf
    s_nop 1
    v_add_f32_dpp v71, v71, v71 quad_perm:[2,3,0,1] row_mask:0xf bank_mask:0xf
    s_nop 1
    v_add_f32_dpp v71, v71, v71 row_half_mirror row_mask:0xf bank_mask:0xf
    s_nop 1
    v_add_f32_dpp v71, v71, v71 row_mirror row_mask:0xf bank_mask:0xf
    ds_swizzle_b32 v72, v71 offset:0x401F
    s_waitcnt lgkmcnt(0)
    v_add_f32 v71, v71, v72
    v_mul_f32 v71, 0x3ae38e39, v71
    v_cvt_pk_bf16_f32 v71, v70, v71
    v_lshlrev_b32 v70, 16, v71
    v_and_b32 v71, 0xffff0000, v71
    v_add_f32 v71, 0x3727c5ac, v71
    v_cvt_pk_bf16_f32 v71, v71, v71
    v_lshlrev_b32 v71, 16, v71
    v_sqrt_f32 v71, v71
    s_nop 0
    v_cvt_pk_bf16_f32 v71, v71, v71
    v_lshlrev_b32 v71, 16, v71
    v_rcp_f32 v71, v71
    s_nop 0
    v_sub_f32 v10, v10, v70
    v_sub_f32 v11, v11, v70
    v_cvt_pk_bf16_f32 v11, v10, v11
    v_lshlrev_b32 v10, 16, v11
    v_and_b32 v11, 0xffff0000, v11
    v_mul_f32 v10, v10, v71
    v_mul_f32 v11, v11, v71
    v_cvt_pk_bf16_f32 v11, v10, v11
    v_lshlrev_b32 v10, 16, v11
    v_and_b32 v11, 0xffff0000, v11
    v_sub_f32 v12, v12, v70
    v_sub_f32 v13, v13, v70
    v_cvt_pk_bf16_f32 v13, v12, v13
    v_lshlrev_b32 v12, 16, v13
    v_and_b32 v13, 0xffff0000, v13
    v_mul_f32 v12, v12, v71
    v_mul_f32 v13, v13, v71
    v_cvt_pk_bf16_f32 v13, v12, v13
    v_lshlrev_b32 v12, 16, v13
    v_and_b32 v13, 0xffff0000, v13
    v_sub_f32 v14, v14, v70
    v_sub_f32 v15, v15, v70
    v_cvt_pk_bf16_f32 v15, v14, v15
    v_lshlrev_b32 v14, 16, v15
    v_and_b32 v15, 0xffff0000, v15
    v_mul_f32 v14, v14, v71
    v_mul_f32 v15, v15, v71
    v_cvt_pk_bf16_f32 v15, v14, v15
    v_lshlrev_b32 v14, 16, v15
    v_and_b32 v15, 0xffff0000, v15
    v_sub_f32 v16, v16, v70
    v_sub_f32 v17, v17, v70
    v_cvt_pk_bf16_f32 v17, v16, v17
    v_lshlrev_b32 v16, 16, v17
    v_and_b32 v17, 0xffff0000, v17
    v_mul_f32 v16, v16, v71
    v_mul_f32 v17, v17, v71
    v_cvt_pk_bf16_f32 v17, v16, v17
    v_lshlrev_b32 v16, 16, v17
    v_and_b32 v17, 0xffff0000, v17
    v_sub_f32 v18, v18, v70
    v_sub_f32 v19, v19, v70
    v_cvt_pk_bf16_f32 v19, v18, v19
    v_lshlrev_b32 v18, 16, v19
    v_and_b32 v19, 0xffff0000, v19
    v_mul_f32 v18, v18, v71
    v_mul_f32 v19, v19, v71
    v_cvt_pk_bf16_f32 v19, v18, v19
    v_lshlrev_b32 v18, 16, v19
    v_and_b32 v19, 0xffff0000, v19
    v_sub_f32 v20, v20, v70
    v_sub_f32 v21, v21, v70
    v_cvt_pk_bf16_f32 v21, v20, v21
    v_lshlrev_b32 v20, 16, v21
    v_and_b32 v21, 0xffff0000, v21
    v_mul_f32 v20, v20, v71
    v_mul_f32 v21, v21, v71
    v_cvt_pk_bf16_f32 v21, v20, v21
    v_lshlrev_b32 v20, 16, v21
    v_and_b32 v21, 0xffff0000, v21
    v_sub_f32 v22, v22, v70
    v_sub_f32 v23, v23, v70
    v_cvt_pk_bf16_f32 v23, v22, v23
    v_lshlrev_b32 v22, 16, v23
    v_and_b32 v23, 0xffff0000, v23
    v_mul_f32 v22, v22, v71
    v_mul_f32 v23, v23, v71
    v_cvt_pk_bf16_f32 v23, v22, v23
    v_lshlrev_b32 v22, 16, v23
    v_and_b32 v23, 0xffff0000, v23
    v_sub_f32 v24, v24, v70
    v_sub_f32 v25, v25, v70
    v_cvt_pk_bf16_f32 v25, v24, v25
    v_lshlrev_b32 v24, 16, v25
    v_and_b32 v25, 0xffff0000, v25
    v_mul_f32 v24, v24, v71
    v_mul_f32 v25, v25, v71
    v_cvt_pk_bf16_f32 v25, v24, v25
    v_lshlrev_b32 v24, 16, v25
    v_and_b32 v25, 0xffff0000, v25
    v_sub_f32 v26, v26, v70
    v_sub_f32 v27, v27, v70
    v_cvt_pk_bf16_f32 v27, v26, v27
    v_lshlrev_b32 v26, 16, v27
    v_and_b32 v27, 0xffff0000, v27
    v_mul_f32 v26, v26, v71
    v_mul_f32 v27, v27, v71
    v_cvt_pk_bf16_f32 v27, v26, v27
    v_lshlrev_b32 v26, 16, v27
    v_and_b32 v27, 0xffff0000, v27
    v_add_f32 v74, v11, v27
    v_sub_f32 v82, v11, v27
    v_add_f32 v75, v12, v26
    v_sub_f32 v83, v12, v26
    v_add_f32 v76, v13, v25
    v_sub_f32 v84, v13, v25
    v_add_f32 v77, v14, v24
    v_sub_f32 v85, v14, v24
    v_add_f32 v78, v15, v23
    v_sub_f32 v86, v15, v23
    v_add_f32 v79, v16, v22
    v_sub_f32 v87, v16, v22
    v_add_f32 v80, v17, v21
    v_sub_f32 v88, v17, v21
    v_add_f32 v81, v18, v20
    v_sub_f32 v89, v18, v20
    v_add_f32 v90, v74, v81
    v_sub_f32 v94, v74, v81
    v_add_f32 v98, v82, v89
    v_sub_f32 v102, v82, v89
    v_add_f32 v91, v75, v80
    v_sub_f32 v95, v75, v80
    v_add_f32 v99, v83, v88
    v_sub_f32 v103, v83, v88
    v_add_f32 v92, v76, v79
    v_sub_f32 v96, v76, v79
    v_add_f32 v100, v84, v87
    v_sub_f32 v104, v84, v87
    v_add_f32 v93, v77, v78
    v_sub_f32 v97, v77, v78
    v_add_f32 v101, v85, v86
    v_sub_f32 v105, v85, v86
    v_add_f32 v106, v10, v19
    v_sub_f32 v107, v10, v19
    v_mul_u32_u24 v3, 144, v1
    v_lshl_add_u32 v3, v2, 2, v3
    v_fmamk_f32 v74, v90, 0x3f800000, v106
    v_fmac_f32 v74, 0x3f800000, v91
    v_fmac_f32 v74, 0x3f800000, v92
    v_fmac_f32 v74, 0x3f800000, v93
    v_mul_f32 v74, 0x3e715bef, v74
    v_cvt_pk_f16_f32 v78, v74, 0
    ds_write_b32 v3, v78 offset:0
    v_fmamk_f32 v74, v94, 0x3f708fb2, v107
    v_fmac_f32 v74, 0x3f441b7d, v95
    v_fmac_f32 v74, 0x3f000000, v96
    v_fmac_f32 v74, 0x3e31d0d4, v97
    v_mul_f32 v75, 0xbeaf1d44, v98
    v_fmac_f32 v75, 0xbf248dbb, v99
    v_fmac_f32 v75, 0xbf5db3d7, v100
    v_fmac_f32 v75, 0xbf7c1c5c, v101
    v_mul_f32 v76, v74, v30
    v_mul_f32 v77, v75, v30
    v_fmac_f32 v76, v75, v31
    v_fma_f32 v77, -v74, v31, v77
    v_cvt_pk_f16_f32 v78, v76, v77
    ds_write_b32 v3, v78 offset:1152
    v_fmamk_f32 v74, v90, 0x3f441b7d, v106
    v_fmac_f32 v74, 0x3e31d0d4, v91
    v_fmac_f32 v74, 0xbf000000, v92
    v_fmac_f32 v74, 0xbf708fb2, v93
    v_mul_f32 v75, 0xbf248dbb, v102
    v_fmac_f32 v75, 0xbf7c1c5c, v103
    v_fmac_f32 v75, 0xbf5db3d7, v104
    v_fmac_f32 v75, 0xbeaf1d44, v105
    v_mul_f32 v76, v74, v32
    v_mul_f32 v77, v75, v32
    v_fmac_f32 v76, v75, v33
    v_fma_f32 v77, -v74, v33, v77
    v_cvt_pk_f16_f32 v78, v76, v77
    ds_write_b32 v3, v78 offset:2304
    v_fmamk_f32 v74, v94, 0x3f000000, v107
    v_fmac_f32 v74, 0xbf000000, v95
    v_fmac_f32 v74, 0xbf800000, v96
    v_fmac_f32 v74, 0xbf000000, v97
    v_mul_f32 v75, 0xbf5db3d7, v98
    v_fmac_f32 v75, 0xbf5db3d7, v99
    v_fmac_f32 v75, 0xa50d3132, v100
    v_fmac_f32 v75, 0x3f5db3d7, v101
    v_mul_f32 v76, v74, v34
    v_mul_f32 v77, v75, v34
    v_fmac_f32 v76, v75, v35
    v_fma_f32 v77, -v74, v35, v77
    v_cvt_pk_f16_f32 v78, v76, v77
    ds_write_b32 v3, v78 offset:3456
    v_fmamk_f32 v74, v90, 0x3e31d0d4, v106
    v_fmac_f32 v74, 0xbf708fb2, v91
    v_fmac_f32 v74, 0xbf000000, v92
    v_fmac_f32 v74, 0x3f441b7d, v93
    v_mul_f32 v75, 0xbf7c1c5c, v102
    v_fmac_f32 v75, 0xbeaf1d44, v103
    v_fmac_f32 v75, 0x3f5db3d7, v104
    v_fmac_f32 v75, 0x3f248dbb, v105
    v_mul_f32 v76, v74, v36
    v_mul_f32 v77, v75, v36
    v_fmac_f32 v76, v75, v37
    v_fma_f32 v77, -v74, v37, v77
    v_cvt_pk_f16_f32 v78, v76, v77
    ds_write_b32 v3, v78 offset:4608
    v_fmamk_f32 v74, v94, 0xbe31d0d4, v107
    v_fmac_f32 v74, 0xbf708fb2, v95
    v_fmac_f32 v74, 0x3f000000, v96
    v_fmac_f32 v74, 0x3f441b7d, v97
    v_mul_f32 v75, 0xbf7c1c5c, v98
    v_fmac_f32 v75, 0x3eaf1d44, v99
    v_fmac_f32 v75, 0x3f5db3d7, v100
    v_fmac_f32 v75, 0xbf248dbb, v101
    v_mul_f32 v76, v74, v38
    v_mul_f32 v77, v75, v38
    v_fmac_f32 v76, v75, v39
    v_fma_f32 v77, -v74, v39, v77
    v_cvt_pk_f16_f32 v78, v76, v77
    ds_write_b32 v3, v78 offset:5760
    v_fmamk_f32 v74, v90, 0xbf000000, v106
    v_fmac_f32 v74, 0xbf000000, v91
    v_fmac_f32 v74, 0x3f800000, v92
    v_fmac_f32 v74, 0xbf000000, v93
    v_mul_f32 v75, 0xbf5db3d7, v102
    v_fmac_f32 v75, 0x3f5db3d7, v103
    v_fmac_f32 v75, 0x258d3132, v104
    v_fmac_f32 v75, 0xbf5db3d7, v105
    v_mul_f32 v76, v74, v40
    v_mul_f32 v77, v75, v40
    v_fmac_f32 v76, v75, v41
    v_fma_f32 v77, -v74, v41, v77
    v_cvt_pk_f16_f32 v78, v76, v77
    ds_write_b32 v3, v78 offset:6912
    v_fmamk_f32 v74, v94, 0xbf441b7d, v107
    v_fmac_f32 v74, 0x3e31d0d4, v95
    v_fmac_f32 v74, 0x3f000000, v96
    v_fmac_f32 v74, 0xbf708fb2, v97
    v_mul_f32 v75, 0xbf248dbb, v98
    v_fmac_f32 v75, 0x3f7c1c5c, v99
    v_fmac_f32 v75, 0xbf5db3d7, v100
    v_fmac_f32 v75, 0x3eaf1d44, v101
    v_mul_f32 v76, v74, v42
    v_mul_f32 v77, v75, v42
    v_fmac_f32 v76, v75, v43
    v_fma_f32 v77, -v74, v43, v77
    v_cvt_pk_f16_f32 v78, v76, v77
    ds_write_b32 v3, v78 offset:8064
    v_fmamk_f32 v74, v90, 0xbf708fb2, v106
    v_fmac_f32 v74, 0x3f441b7d, v91
    v_fmac_f32 v74, 0xbf000000, v92
    v_fmac_f32 v74, 0x3e31d0d4, v93
    v_mul_f32 v75, 0xbeaf1d44, v102
    v_fmac_f32 v75, 0x3f248dbb, v103
    v_fmac_f32 v75, 0xbf5db3d7, v104
    v_fmac_f32 v75, 0x3f7c1c5c, v105
    v_mul_f32 v76, v74, v44
    v_mul_f32 v77, v75, v44
    v_fmac_f32 v76, v75, v45
    v_fma_f32 v77, -v74, v45, v77
    v_cvt_pk_f16_f32 v78, v76, v77
    ds_write_b32 v3, v78 offset:9216
    v_fmamk_f32 v74, v94, 0xbf800000, v107
    v_fmac_f32 v74, 0x3f800000, v95
    v_fmac_f32 v74, 0xbf800000, v96
    v_fmac_f32 v74, 0x3f800000, v97
    v_mul_f32 v76, v74, v46
    v_mul_f32 v77, v74, v47
    v_cvt_pk_f16_f32 v78, v76, -v77
    ds_write_b32 v3, v78 offset:10368
    s_lshr_b32 s12, s13, 1
    s_mul_i32 s12, s12, 6912
    v_mul_u32_u24 v3, 144, v8
    v_lshl_add_u32 v3, v9, 4, v3
    v_add_u32 v3, s12, v3
    s_waitcnt lgkmcnt(0)
    s_barrier
    ds_read_b128 v[10:13], v3 offset:0
    ds_read_b128 v[14:17], v3 offset:64
    ds_read_b128 v[18:21], v3 offset:2304
    ds_read_b128 v[22:25], v3 offset:2368
    ds_read_b128 v[26:29], v3 offset:4608
    ds_read_b128 v[30:33], v3 offset:4672
    s_lshr_b32 s12, s13, 1
    s_mul_i32 s12, s12, 6
    v_lshrrev_b32 v4, 1, v9
    v_add_u32 v4, s12, v4
    v_mul_u32_u24 v5, 18, v64
    v_and_b32 v6, 1, v9
    s_lshl_b32 s12, s3, 1
    v_add_u32 v6, s12, v6
    v_lshlrev_b32 v6, 4, v6
    v_mov_b32 v7, 0x7fffff00
    s_waitcnt lgkmcnt(4)
    v_mfma_f32_16x16x32_f16 v[74:77], v[10:13], v[48:51], 0
    v_mfma_f32_16x16x32_f16 v[74:77], v[14:17], v[52:55], v[74:77]
    v_mfma_f32_16x16x32_f16 v[78:81], v[10:13], v[56:59], 0
    v_mfma_f32_16x16x32_f16 v[78:81], v[14:17], v[60:63], v[78:81]
    s_waitcnt lgkmcnt(2)
    v_mfma_f32_16x16x32_f16 v[82:85], v[18:21], v[48:51], 0
    v_mfma_f32_16x16x32_f16 v[82:85], v[22:25], v[52:55], v[82:85]
    v_mfma_f32_16x16x32_f16 v[86:89], v[18:21], v[56:59], 0
    v_mfma_f32_16x16x32_f16 v[86:89], v[22:25], v[60:63], v[86:89]
    s_waitcnt lgkmcnt(0)
    v_mfma_f32_16x16x32_f16 v[90:93], v[26:29], v[48:51], 0
    v_mfma_f32_16x16x32_f16 v[90:93], v[30:33], v[52:55], v[90:93]
    v_mfma_f32_16x16x32_f16 v[94:97], v[26:29], v[56:59], 0
    v_mfma_f32_16x16x32_f16 v[94:97], v[30:33], v[60:63], v[94:97]
    v_add_u32 v36, 0, v4
    v_add_u32 v37, v5, v36
    v_sub_u32 v38, 576, v37
    s_cmp_eq_u32 s14, 1
    s_cselect_b64 vcc, -1, 0
    v_cndmask_b32 v37, v37, v38, vcc
    v_lshl_add_u32 v39, v37, 13, v6
    v_cmp_lt_u32 vcc, 9, v36
    s_nop 1
    v_cndmask_b32 v39, v39, v7, vcc
    v_cmp_eq_u32 s[24:25], 9, v36
    v_cmp_eq_u32 s[26:27], 0, v36
    v_cmp_ne_u32 vcc, 0x120, v37
    s_nop 1
    s_and_b64 s[26:27], s[26:27], vcc
    s_or_b64 s[24:25], s[24:25], s[26:27]
    s_cmp_eq_u32 s14, 1
    s_cselect_b64 vcc, s[24:25], 0
    v_cndmask_b32 v40, v39, v7, vcc
    v_add_u32 v36, 2, v4
    v_add_u32 v37, v5, v36
    v_sub_u32 v38, 576, v37
    s_cmp_eq_u32 s14, 1
    s_cselect_b64 vcc, -1, 0
    v_cndmask_b32 v37, v37, v38, vcc
    v_lshl_add_u32 v39, v37, 13, v6
    v_cmp_lt_u32 vcc, 9, v36
    s_nop 1
    v_cndmask_b32 v39, v39, v7, vcc
    v_cmp_eq_u32 s[24:25], 9, v36
    v_cmp_eq_u32 s[26:27], 0, v36
    v_cmp_ne_u32 vcc, 0x120, v37
    s_nop 1
    s_and_b64 s[26:27], s[26:27], vcc
    s_or_b64 s[24:25], s[24:25], s[26:27]
    s_cmp_eq_u32 s14, 1
    s_cselect_b64 vcc, s[24:25], 0
    v_cndmask_b32 v41, v39, v7, vcc
    v_add_u32 v36, 4, v4
    v_add_u32 v37, v5, v36
    v_sub_u32 v38, 576, v37
    s_cmp_eq_u32 s14, 1
    s_cselect_b64 vcc, -1, 0
    v_cndmask_b32 v37, v37, v38, vcc
    v_lshl_add_u32 v39, v37, 13, v6
    v_cmp_lt_u32 vcc, 9, v36
    s_nop 1
    v_cndmask_b32 v39, v39, v7, vcc
    v_cmp_eq_u32 s[24:25], 9, v36
    v_cmp_eq_u32 s[26:27], 0, v36
    v_cmp_ne_u32 vcc, 0x120, v37
    s_nop 1
    s_and_b64 s[26:27], s[26:27], vcc
    s_or_b64 s[24:25], s[24:25], s[26:27]
    s_cmp_eq_u32 s14, 1
    s_cselect_b64 vcc, s[24:25], 0
    v_cndmask_b32 v42, v39, v7, vcc
    s_nop 7
    v_cvt_pk_f16_f32 v74, v74, v75
    v_cvt_pk_f16_f32 v75, v76, v77
    v_cvt_pk_f16_f32 v76, v78, v79
    v_cvt_pk_f16_f32 v77, v80, v81
    buffer_store_dwordx4 v[74:77], v40, s[20:23], 0 offen
    v_cvt_pk_f16_f32 v82, v82, v83
    v_cvt_pk_f16_f32 v83, v84, v85
    v_cvt_pk_f16_f32 v84, v86, v87
    v_cvt_pk_f16_f32 v85, v88, v89
    buffer_store_dwordx4 v[82:85], v41, s[20:23], 0 offen
    v_cvt_pk_f16_f32 v90, v90, v91
    v_cvt_pk_f16_f32 v91, v92, v93
    v_cvt_pk_f16_f32 v92, v94, v95
    v_cvt_pk_f16_f32 v93, v96, v97
    buffer_store_dwordx4 v[90:93], v42, s[20:23], 0 offen
    s_endpgm
K1_TR:
    s_sub_u32 s3, s2, 256
    s_lshl_b32 s12, s3, 8
    v_add_u32 v1, s12, v0
    s_mov_b32 s12, 14861479
    v_mul_hi_u32 v2, v1, s12
    v_mul_u32_u24 v3, 289, v2
    v_sub_u32 v3, v1, v3
    v_and_b32 v4, 63, v2
    v_lshrrev_b32 v5, 6, v2
    v_lshl_add_u32 v6, v5, 10, v4
    v_mul_u32_u24 v6, 578, v6
    v_lshl_add_u32 v6, v3, 1, v6
    s_waitcnt lgkmcnt(0)
    s_mov_b32 s16, s6
    s_mov_b32 s17, s7
    s_mov_b32 s18, 0x121000
    s_mov_b32 s19, 0x20000
    s_mov_b32 s20, s8
    s_mov_b32 s21, s9
    s_mov_b32 s22, 0x121000
    s_mov_b32 s23, 0x20000
    s_add_u32 s24, s10, 0x250000
    s_addc_u32 s25, s11, 0
    s_mov_b32 s26, 0x242000
    s_mov_b32 s27, 0x20000
    s_add_u32 s28, s10, 0x942000
    s_addc_u32 s29, s11, 0
    s_mov_b32 s30, 0x910
    s_mov_b32 s31, 0x20000
    s_add_u32 s32, s10, 0xb00000
    s_addc_u32 s33, s11, 0
    s_mov_b32 s34, 0xa2000
    s_mov_b32 s35, 0x20000
    s_add_u32 s36, s10, 0x94e000
    s_addc_u32 s37, s11, 0
    s_mov_b32 s38, 0x6000
    s_mov_b32 s39, 0x20000
    s_mov_b32 s13, 0
    buffer_load_ushort v10, v6, s[16:19], s13 offen
    buffer_load_ushort v30, v6, s[20:23], s13 offen
    s_mov_b32 s13, 36992
    buffer_load_ushort v11, v6, s[16:19], s13 offen
    buffer_load_ushort v31, v6, s[20:23], s13 offen
    s_mov_b32 s13, 73984
    buffer_load_ushort v12, v6, s[16:19], s13 offen
    buffer_load_ushort v32, v6, s[20:23], s13 offen
    s_mov_b32 s13, 110976
    buffer_load_ushort v13, v6, s[16:19], s13 offen
    buffer_load_ushort v33, v6, s[20:23], s13 offen
    s_mov_b32 s13, 147968
    buffer_load_ushort v14, v6, s[16:19], s13 offen
    buffer_load_ushort v34, v6, s[20:23], s13 offen
    s_mov_b32 s13, 184960
    buffer_load_ushort v15, v6, s[16:19], s13 offen
    buffer_load_ushort v35, v6, s[20:23], s13 offen
    s_mov_b32 s13, 221952
    buffer_load_ushort v16, v6, s[16:19], s13 offen
    buffer_load_ushort v36, v6, s[20:23], s13 offen
    s_mov_b32 s13, 258944
    buffer_load_ushort v17, v6, s[16:19], s13 offen
    buffer_load_ushort v37, v6, s[20:23], s13 offen
    s_mov_b32 s13, 295936
    buffer_load_ushort v18, v6, s[16:19], s13 offen
    buffer_load_ushort v38, v6, s[20:23], s13 offen
    s_mov_b32 s13, 332928
    buffer_load_ushort v19, v6, s[16:19], s13 offen
    buffer_load_ushort v39, v6, s[20:23], s13 offen
    s_mov_b32 s13, 369920
    buffer_load_ushort v20, v6, s[16:19], s13 offen
    buffer_load_ushort v40, v6, s[20:23], s13 offen
    s_mov_b32 s13, 406912
    buffer_load_ushort v21, v6, s[16:19], s13 offen
    buffer_load_ushort v41, v6, s[20:23], s13 offen
    s_mov_b32 s13, 443904
    buffer_load_ushort v22, v6, s[16:19], s13 offen
    buffer_load_ushort v42, v6, s[20:23], s13 offen
    s_mov_b32 s13, 480896
    buffer_load_ushort v23, v6, s[16:19], s13 offen
    buffer_load_ushort v43, v6, s[20:23], s13 offen
    s_mov_b32 s13, 517888
    buffer_load_ushort v24, v6, s[16:19], s13 offen
    buffer_load_ushort v44, v6, s[20:23], s13 offen
    s_mov_b32 s13, 554880
    buffer_load_ushort v25, v6, s[16:19], s13 offen
    buffer_load_ushort v45, v6, s[20:23], s13 offen
    v_lshrrev_b32 v7, 4, v4
    v_lshlrev_b32 v7, 6, v7
    v_and_b32 v8, 15, v4
    v_add_u32 v7, v7, v8
    v_lshlrev_b32 v7, 5, v7
    v_lshl_add_u32 v7, v5, 4, v7
    v_lshl_add_u32 v7, v3, 13, v7
    v_mov_b32 v8, 0x7fff0000
    v_cmp_le_u32 vcc, 0x9080, v1
    v_mov_b32 v50, 0
    v_mov_b32 v51, 0
    v_cndmask_b32 v7, v7, v8, vcc
    v_mov_b32 v52, 0
    v_mov_b32 v53, 0
    v_lshlrev_b32 v9, 4, v1
    buffer_store_dwordx4 v[50:53], v9, s[36:39], 0 offen
    v_mov_b32 v60, -1
    v_mov_b32 v61, -1
    v_mov_b32 v62, -1
    v_mov_b32 v63, -1
    buffer_store_dwordx4 v[60:63], v9, s[32:35], 0 offen
    v_add_u32 v9, 0x91000, v9
    buffer_store_dwordx4 v[60:63], v9, s[32:35], 0 offen
    s_waitcnt vmcnt(3)
    v_lshl_or_b32 v10, v30, 16, v10
    v_lshl_or_b32 v11, v31, 16, v11
    v_lshl_or_b32 v12, v32, 16, v12
    v_lshl_or_b32 v13, v33, 16, v13
    v_lshl_or_b32 v14, v34, 16, v14
    v_lshl_or_b32 v15, v35, 16, v15
    v_lshl_or_b32 v16, v36, 16, v16
    v_lshl_or_b32 v17, v37, 16, v17
    v_lshl_or_b32 v18, v38, 16, v18
    v_lshl_or_b32 v19, v39, 16, v19
    v_lshl_or_b32 v20, v40, 16, v20
    v_lshl_or_b32 v21, v41, 16, v21
    v_lshl_or_b32 v22, v42, 16, v22
    v_lshl_or_b32 v23, v43, 16, v23
    v_lshl_or_b32 v24, v44, 16, v24
    v_lshl_or_b32 v25, v45, 16, v25
    v_and_b32 v54, 0x7fff7fff, v10
    v_and_b32 v55, 0x7fff7fff, v11
    v_pk_max_u16 v54, v54, v55
    v_and_b32 v55, 0x7fff7fff, v12
    v_pk_max_u16 v54, v54, v55
    v_and_b32 v55, 0x7fff7fff, v13
    v_pk_max_u16 v54, v54, v55
    v_and_b32 v55, 0x7fff7fff, v14
    v_pk_max_u16 v54, v54, v55
    v_and_b32 v55, 0x7fff7fff, v15
    v_pk_max_u16 v54, v54, v55
    v_and_b32 v55, 0x7fff7fff, v16
    v_pk_max_u16 v54, v54, v55
    v_and_b32 v55, 0x7fff7fff, v17
    v_pk_max_u16 v54, v54, v55
    v_and_b32 v55, 0x7fff7fff, v18
    v_pk_max_u16 v54, v54, v55
    v_and_b32 v55, 0x7fff7fff, v19
    v_pk_max_u16 v54, v54, v55
    v_and_b32 v55, 0x7fff7fff, v20
    v_pk_max_u16 v54, v54, v55
    v_and_b32 v55, 0x7fff7fff, v21
    v_pk_max_u16 v54, v54, v55
    v_and_b32 v55, 0x7fff7fff, v22
    v_pk_max_u16 v54, v54, v55
    v_and_b32 v55, 0x7fff7fff, v23
    v_pk_max_u16 v54, v54, v55
    v_and_b32 v55, 0x7fff7fff, v24
    v_pk_max_u16 v54, v54, v55
    v_and_b32 v55, 0x7fff7fff, v25
    v_pk_max_u16 v54, v54, v55
    buffer_store_dwordx4 v[10:13], v7, s[24:27], 0 offen offset:0
    buffer_store_dwordx4 v[14:17], v7, s[24:27], 0 offen offset:512
    buffer_store_dwordx4 v[18:21], v7, s[24:27], 0 offen offset:1024
    buffer_store_dwordx4 v[22:25], v7, s[24:27], 0 offen offset:1536
    v_lshrrev_b32 v55, 16, v54
    v_and_b32 v54, 0xffff, v54
    v_max_u32 v54, v54, v55
    s_nop 1
    v_max_u32_dpp v54, v54, v54 quad_perm:[1,0,3,2] row_mask:0xf bank_mask:0xf
    s_nop 1
    v_max_u32_dpp v54, v54, v54 quad_perm:[2,3,0,1] row_mask:0xf bank_mask:0xf
    s_nop 1
    v_max_u32_dpp v54, v54, v54 row_half_mirror row_mask:0xf bank_mask:0xf
    s_nop 1
    v_max_u32_dpp v54, v54, v54 row_mirror row_mask:0xf bank_mask:0xf
    ds_swizzle_b32 v55, v54 offset:0x401F
    s_waitcnt lgkmcnt(0)
    v_max_u32 v54, v54, v55
    s_nop 1
    v_readlane_b32 s13, v54, 0
    v_readlane_b32 s14, v54, 32
    s_nop 3
    s_max_u32 s13, s13, s14
    v_lshrrev_b32 v56, 6, v0
    s_lshl_b32 s14, s3, 2
    v_add_lshl_u32 v56, v56, s14, 2
    v_mov_b32 v57, s13
    v_and_b32 v58, 63, v0
    v_cmp_eq_u32 vcc, 0, v58
    s_and_saveexec_b64 s[14:15], vcc
    buffer_store_dword v57, v56, s[28:31], 0 offen
K1_END:
    s_endpgm
K1_PF:
    s_sub_u32 s3, s2, 408
    s_cmp_ge_u32 s3, 144
    s_cbranch_scc1 K1_END
    s_load_dwordx4 s[4:7], s[0:1], 40
    s_load_dwordx2 s[8:9], s[0:1], 56
    s_and_b32 s12, s3, 0xf0
    s_and_b32 s13, s3, 7
    s_lshl_b32 s13, s13, 1
    s_or_b32 s12, s12, s13
    s_bfe_u32 s13, s3, 0x10003
    s_or_b32 s12, s12, s13
    v_and_b32 v1, 7, v0
    v_lshrrev_b32 v2, 3, v0
    v_mul_u32_u24 v3, 9216, v2
    v_lshl_add_u32 v3, v1, 4, v3
    s_lshr_b32 s13, s12, 1
    s_lshl_b32 s13, s13, 7
    s_and_b32 s14, s12, 1
    s_mul_i32 s14, s14, 2654208
    s_add_u32 s13, s13, s14
    v_add_u32 v3, s13, v3
    v_lshlrev_b32 v4, 4, v0
    s_mul_i32 s12, s12, 36864
    s_waitcnt lgkmcnt(0)
    s_mov_b32 s16, s4
    s_mov_b32 s17, s5
    s_mov_b32 s18, 0x510000
    s_mov_b32 s19, 0x20000
    s_mov_b32 s20, s6
    s_mov_b32 s21, s7
    s_mov_b32 s22, 0x510000
    s_mov_b32 s23, 0x20000
    s_mov_b32 s24, s8
    s_mov_b32 s25, s9
    s_mov_b32 s26, 0x510000
    s_mov_b32 s27, 0x20000
    s_mov_b32 s3, 0
    buffer_load_dwordx4 v[8:11], v3, s[16:19], s3 offen
    s_mov_b32 s3, 294912
    buffer_load_dwordx4 v[12:15], v3, s[16:19], s3 offen
    s_mov_b32 s3, 589824
    buffer_load_dwordx4 v[16:19], v3, s[16:19], s3 offen
    s_mov_b32 s3, 884736
    buffer_load_dwordx4 v[20:23], v3, s[16:19], s3 offen
    s_mov_b32 s3, 1179648
    buffer_load_dwordx4 v[24:27], v3, s[16:19], s3 offen
    s_mov_b32 s3, 1474560
    buffer_load_dwordx4 v[28:31], v3, s[16:19], s3 offen
    s_mov_b32 s3, 1769472
    buffer_load_dwordx4 v[32:35], v3, s[16:19], s3 offen
    s_mov_b32 s3, 2064384
    buffer_load_dwordx4 v[36:39], v3, s[16:19], s3 offen
    s_mov_b32 s3, 2359296
    buffer_load_dwordx4 v[40:43], v3, s[16:19], s3 offen
    s_waitcnt vmcnt(0)
    s_endpgm
.globl fb_kernel
.p2align 8
.type fb_kernel,@function
fb_kernel:
    s_cmp_ge_u32 s2, 289
    s_cbranch_scc1 K2_PF
    s_load_dwordx2 s[10:11], s[0:1], 80
    v_lshrrev_b32 v6, 6, v0
    v_and_b32 v7, 63, v0
    v_and_b32 v8, 15, v0
    v_readfirstlane_b32 s13, v6
    v_lshrrev_b32 v9, 4, v7
    s_lshl_b32 s3, s2, 13
    v_lshlrev_b32 v1, 8, v8
    v_lshl_add_u32 v1, v9, 4, v1
    v_lshlrev_b32 v2, 5, v0
    s_waitcnt lgkmcnt(0)
    s_mov_b32 s16, s10
    s_mov_b32 s17, s11
    s_mov_b32 s18, 0x242000
    s_mov_b32 s19, 0x20000
    s_add_u32 s20, s10, 0x250000
    s_addc_u32 s21, s11, 0
    s_mov_b32 s22, 0x242000
    s_mov_b32 s23, 0x20000
    s_add_u32 s24, s10, 0x4a0000
    s_addc_u32 s25, s11, 0
    s_mov_b32 s26, 0x242000
    s_mov_b32 s27, 0x20000
    s_add_u32 s28, s10, 0x942000
    s_addc_u32 s29, s11, 0
    s_mov_b32 s30, 0x910
    s_mov_b32 s31, 0x20000
    v_add_u32 v3, 0x1000, v1
    buffer_load_dwordx4 v[10:13], v1, s[16:19], s3 offen offset:0
    buffer_load_dwordx4 v[14:17], v1, s[16:19], s3 offen offset:64
    buffer_load_dwordx4 v[18:21], v1, s[16:19], s3 offen offset:128
    buffer_load_dwordx4 v[22:25], v1, s[16:19], s3 offen offset:192
    buffer_load_dwordx4 v[26:29], v3, s[16:19], s3 offen offset:0
    buffer_load_dwordx4 v[30:33], v3, s[16:19], s3 offen offset:64
    buffer_load_dwordx4 v[34:37], v3, s[16:19], s3 offen offset:128
    buffer_load_dwordx4 v[38:41], v3, s[16:19], s3 offen offset:192
    buffer_load_dwordx4 v[42:45], v2, s[20:23], s3 offen
    buffer_load_dwordx4 v[46:49], v2, s[20:23], s3 offen offset:16
    v_mul_u32_u24 v160, 48, v7
    buffer_load_dwordx4 v[148:151], v160, s[28:31], 0 offen offset:0
    buffer_load_dwordx4 v[152:155], v160, s[28:31], 0 offen offset:16
    buffer_load_dwordx4 v[156:159], v160, s[28:31], 0 offen offset:32
    s_lshl_b32 s14, s13, 4
    v_add_u32 v4, s14, v8
    v_cvt_f32_u32 v4, v4
    v_lshlrev_b32 v5, 2, v9
    v_cvt_f32_u32 v5, v5
    v_and_b32 v146, 1, v8
    v_mul_u32_u24 v146, 0x8000, v146
    v_lshl_or_b32 v146, v146, 16, v146
    v_mul_f32 v147, 0x3c800000, v4
    v_add_f32 v170, 0.0, v5
    v_mul_f32 v170, v170, v147
    v_cos_f32 v162, v170
    v_sin_f32 v166, v170
    s_nop 0
    v_mul_f32 v162, 0x3e000000, v162
    v_mul_f32 v166, 0x3e000000, v166
    v_add_f32 v170, 1.0, v5
    v_mul_f32 v170, v170, v147
    v_cos_f32 v163, v170
    v_sin_f32 v167, v170
    s_nop 0
    v_mul_f32 v163, 0x3e000000, v163
    v_mul_f32 v167, 0x3e000000, v167
    v_add_f32 v170, 2.0, v5
    v_mul_f32 v170, v170, v147
    v_cos_f32 v164, v170
    v_sin_f32 v168, v170
    s_nop 0
    v_mul_f32 v164, 0x3e000000, v164
    v_mul_f32 v168, 0x3e000000, v168
    v_add_f32 v170, 3.0, v5
    v_mul_f32 v170, v170, v147
    v_cos_f32 v165, v170
    v_sin_f32 v169, v170
    s_nop 0
    v_mul_f32 v165, 0x3e000000, v165
    v_mul_f32 v169, 0x3e000000, v169
    v_cvt_pk_f16_f32 v50, v162, v163
    v_cvt_pk_f16_f32 v51, v164, v165
    v_cvt_pk_f16_f32 v52, v166, v167
    v_cvt_pk_f16_f32 v53, v168, v169
    v_xor_b32 v66, 0x80008000, v52
    v_xor_b32 v67, 0x80008000, v53
    v_mov_b32 v68, v50
    v_mov_b32 v69, v51
    v_xor_b32 v58, v146, v50
    v_xor_b32 v74, v146, v66
    v_xor_b32 v59, v146, v51
    v_xor_b32 v75, v146, v67
    v_xor_b32 v60, v146, v52
    v_xor_b32 v76, v146, v68
    v_xor_b32 v61, v146, v53
    v_xor_b32 v77, v146, v69
    v_add_f32 v170, 16.0, v5
    v_mul_f32 v170, v170, v147
    v_cos_f32 v162, v170
    v_sin_f32 v166, v170
    s_nop 0
    v_mul_f32 v162, 0x3e000000, v162
    v_mul_f32 v166, 0x3e000000, v166
    v_add_f32 v170, 17.0, v5
    v_mul_f32 v170, v170, v147
    v_cos_f32 v163, v170
    v_sin_f32 v167, v170
    s_nop 0
    v_mul_f32 v163, 0x3e000000, v163
    v_mul_f32 v167, 0x3e000000, v167
    v_add_f32 v170, 18.0, v5
    v_mul_f32 v170, v170, v147
    v_cos_f32 v164, v170
    v_sin_f32 v168, v170
    s_nop 0
    v_mul_f32 v164, 0x3e000000, v164
    v_mul_f32 v168, 0x3e000000, v168
    v_add_f32 v170, 19.0, v5
    v_mul_f32 v170, v170, v147
    v_cos_f32 v165, v170
    v_sin_f32 v169, v170
    s_nop 0
    v_mul_f32 v165, 0x3e000000, v165
    v_mul_f32 v169, 0x3e000000, v169
    v_cvt_pk_f16_f32 v54, v162, v163
    v_cvt_pk_f16_f32 v55, v164, v165
    v_cvt_pk_f16_f32 v56, v166, v167
    v_cvt_pk_f16_f32 v57, v168, v169
    v_xor_b32 v70, 0x80008000, v56
    v_xor_b32 v71, 0x80008000, v57
    v_mov_b32 v72, v54
    v_mov_b32 v73, v55
    v_xor_b32 v62, v146, v54
    v_xor_b32 v78, v146, v70
    v_xor_b32 v63, v146, v55
    v_xor_b32 v79, v146, v71
    v_xor_b32 v64, v146, v56
    v_xor_b32 v80, v146, v72
    v_xor_b32 v65, v146, v57
    v_xor_b32 v81, v146, v73
    v_cvt_f32_u32 v171, v8
    v_mul_f32 v147, 0x3d000000, v171
    v_add_f32 v170, 0.0, v5
    v_mul_f32 v170, v170, v147
    v_cos_f32 v162, v170
    v_sin_f32 v166, v170
    s_nop 0
    v_mul_f32 v162, 0x3e3504f3, v162
    v_mul_f32 v166, 0x3e3504f3, v166
    v_add_f32 v170, 1.0, v5
    v_mul_f32 v170, v170, v147
    v_cos_f32 v163, v170
    v_sin_f32 v167, v170
    s_nop 0
    v_mul_f32 v163, 0x3e3504f3, v163
    v_mul_f32 v167, 0x3e3504f3, v167
    v_add_f32 v170, 2.0, v5
    v_mul_f32 v170, v170, v147
    v_cos_f32 v164, v170
    v_sin_f32 v168, v170
    s_nop 0
    v_mul_f32 v164, 0x3e3504f3, v164
    v_mul_f32 v168, 0x3e3504f3, v168
    v_add_f32 v170, 3.0, v5
    v_mul_f32 v170, v170, v147
    v_cos_f32 v165, v170
    v_sin_f32 v169, v170
    s_nop 0
    v_mul_f32 v165, 0x3e3504f3, v165
    v_mul_f32 v169, 0x3e3504f3, v169
    v_cvt_pk_f16_f32 v82, v162, v163
    v_cvt_pk_f16_f32 v83, v164, v165
    v_cvt_pk_f16_f32 v84, v166, v167
    v_cvt_pk_f16_f32 v85, v168, v169
    v_xor_b32 v98, 0x80008000, v84
    v_xor_b32 v99, 0x80008000, v85
    v_mov_b32 v100, v82
    v_mov_b32 v101, v83
    v_xor_b32 v86, v146, v82
    v_xor_b32 v90, 0x80000000, v82
    v_xor_b32 v94, 0x80000000, v86
    v_xor_b32 v87, v146, v83
    v_xor_b32 v91, 0x80000000, v83
    v_xor_b32 v95, 0x80000000, v87
    v_xor_b32 v88, v146, v84
    v_xor_b32 v92, 0x80000000, v84
    v_xor_b32 v96, 0x80000000, v88
    v_xor_b32 v89, v146, v85
    v_xor_b32 v93, 0x80000000, v85
    v_xor_b32 v97, 0x80000000, v89
    v_xor_b32 v102, v146, v98
    v_xor_b32 v106, 0x80000000, v98
    v_xor_b32 v110, 0x80000000, v102
    v_xor_b32 v103, v146, v99
    v_xor_b32 v107, 0x80000000, v99
    v_xor_b32 v111, 0x80000000, v103
    v_xor_b32 v104, v146, v100
    v_xor_b32 v108, 0x80000000, v100
    v_xor_b32 v112, 0x80000000, v104
    v_xor_b32 v105, v146, v101
    v_xor_b32 v109, 0x80000000, v101
    v_xor_b32 v113, 0x80000000, v105
    v_mul_f32 v147, 0x3a000000, v4
    v_add_f32 v170, 0.0, v5
    v_mul_f32 v170, v170, v147
    v_cos_f32 v114, v170
    v_sin_f32 v115, v170
    v_add_f32 v170, 1.0, v5
    v_mul_f32 v170, v170, v147
    v_cos_f32 v116, v170
    v_sin_f32 v117, v170
    v_add_f32 v170, 2.0, v5
    v_mul_f32 v170, v170, v147
    v_cos_f32 v118, v170
    v_sin_f32 v119, v170
    v_add_f32 v170, 3.0, v5
    v_mul_f32 v170, v170, v147
    v_cos_f32 v120, v170
    v_sin_f32 v121, v170
    v_add_f32 v170, 16.0, v5
    v_mul_f32 v170, v170, v147
    v_cos_f32 v122, v170
    v_sin_f32 v123, v170
    v_add_f32 v170, 17.0, v5
    v_mul_f32 v170, v170, v147
    v_cos_f32 v124, v170
    v_sin_f32 v125, v170
    v_add_f32 v170, 18.0, v5
    v_mul_f32 v170, v170, v147
    v_cos_f32 v126, v170
    v_sin_f32 v127, v170
    v_add_f32 v170, 19.0, v5
    v_mul_f32 v170, v170, v147
    v_cos_f32 v128, v170
    v_sin_f32 v129, v170
    v_cvt_f32_u32 v169, s14
    v_add_f32 v169, v169, v5
    v_add_f32 v147, 0.0, v171
    v_mul_f32 v147, 0x3a000000, v147
    v_add_f32 v170, 0.0, v169
    v_mul_f32 v170, v170, v147
    v_cos_f32 v130, v170
    v_sin_f32 v131, v170
    v_add_f32 v170, 1.0, v169
    v_mul_f32 v170, v170, v147
    v_cos_f32 v132, v170
    v_sin_f32 v133, v170
    v_add_f32 v170, 2.0, v169
    v_mul_f32 v170, v170, v147
    v_cos_f32 v134, v170
    v_sin_f32 v135, v170
    v_add_f32 v170, 3.0, v169
    v_mul_f32 v170, v170, v147
    v_cos_f32 v136, v170
    v_sin_f32 v137, v170
    v_add_f32 v147, 16.0, v171
    v_mul_f32 v147, 0x3a000000, v147
    v_add_f32 v170, 0.0, v169
    v_mul_f32 v170, v170, v147
    v_cos_f32 v138, v170
    v_sin_f32 v139, v170
    v_add_f32 v170, 1.0, v169
    v_mul_f32 v170, v170, v147
    v_cos_f32 v140, v170
    v_sin_f32 v141, v170
    v_add_f32 v170, 2.0, v169
    v_mul_f32 v170, v170, v147
    v_cos_f32 v142, v170
    v_sin_f32 v143, v170
    v_add_f32 v170, 3.0, v169
    v_mul_f32 v170, v170, v147
    v_cos_f32 v144, v170
    v_sin_f32 v145, v170
    s_mul_i32 s14, s2, 3641
    s_lshr_b32 s14, s14, 16
    s_mul_i32 s14, s14, 18
    s_sub_u32 s14, s2, s14
    s_mov_b32 s15, 1.0
    s_cmp_eq_u32 s14, 0
    s_cselect_b32 s15, 2.0, s15
    s_cmp_eq_u32 s14, 9
    s_cselect_b32 s15, 2.0, s15
    s_cmp_eq_u32 s2, 0
    s_cselect_b32 s15, 1.0, s15
    s_cmp_eq_u32 s2, 288
    s_cselect_b32 s15, 1.0, s15
    v_mul_u32_u24 v1, 272, v8
    v_lshl_add_u32 v1, v9, 4, v1
    s_lshl_b32 s14, s13, 6
    v_add_u32 v2, s14, v1
    s_lshl_b32 s14, s13, 11
    v_lshlrev_b32 v3, 7, v8
    v_lshl_add_u32 v3, v9, 4, v3
    v_add_u32 v3, s14, v3
    s_waitcnt vmcnt(5)
    v_mfma_f32_16x16x32_f16 v[172:175], v[10:13], v[50:53], 0
    v_mfma_f32_16x16x32_f16 v[180:183], v[10:13], v[66:69], 0
    v_mfma_f32_16x16x32_f16 v[172:175], v[14:17], v[54:57], v[172:175]
    v_mfma_f32_16x16x32_f16 v[180:183], v[14:17], v[70:73], v[180:183]
    v_mfma_f32_16x16x32_f16 v[172:175], v[18:21], v[58:61], v[172:175]
    v_mfma_f32_16x16x32_f16 v[180:183], v[18:21], v[74:77], v[180:183]
    v_mfma_f32_16x16x32_f16 v[172:175], v[22:25], v[62:65], v[172:175]
    v_mfma_f32_16x16x32_f16 v[180:183], v[22:25], v[78:81], v[180:183]
    v_mfma_f32_16x16x32_f16 v[176:179], v[26:29], v[50:53], 0
    v_mfma_f32_16x16x32_f16 v[184:187], v[26:29], v[66:69], 0
    v_mfma_f32_16x16x32_f16 v[176:179], v[30:33], v[54:57], v[176:179]
    v_mfma_f32_16x16x32_f16 v[184:187], v[30:33], v[70:73], v[184:187]
    v_mfma_f32_16x16x32_f16 v[176:179], v[34:37], v[58:61], v[176:179]
    v_mfma_f32_16x16x32_f16 v[184:187], v[34:37], v[74:77], v[184:187]
    v_mfma_f32_16x16x32_f16 v[176:179], v[38:41], v[62:65], v[176:179]
    v_mfma_f32_16x16x32_f16 v[184:187], v[38:41], v[78:81], v[184:187]
    s_waitcnt vmcnt(0)
    v_max3_u32 v148, v148, v149, v150
    v_max3_u32 v148, v148, v151, v152
    v_max3_u32 v148, v148, v153, v154
    v_max3_u32 v148, v148, v155, v156
    v_max3_u32 v148, v148, v157, v158
    v_max_u32 v148, v148, v159
    s_nop 1
    v_max_u32_dpp v148, v148, v148 quad_perm:[1,0,3,2] row_mask:0xf bank_mask:0xf
    s_nop 1
    v_max_u32_dpp v148, v148, v148 quad_perm:[2,3,0,1] row_mask:0xf bank_mask:0xf
    s_nop 1
    v_max_u32_dpp v148, v148, v148 row_half_mirror row_mask:0xf bank_mask:0xf
    s_nop 1
    v_max_u32_dpp v148, v148, v148 row_mirror row_mask:0xf bank_mask:0xf
    ds_swizzle_b32 v149, v148 offset:0x401F
    s_waitcnt lgkmcnt(0)
    v_max_u32 v148, v148, v149
    s_nop 1
    v_readlane_b32 s32, v148, 0
    v_readlane_b32 s33, v148, 32
    s_nop 3
    s_max_u32 s32, s32, s33
    s_lshr_b32 s32, s32, 7
    s_max_u32 s32, s32, 1
    s_min_u32 s32, s32, 253
    s_sub_u32 s33, 254, s32
    s_lshl_b32 s33, s33, 23
    v_mul_f32 v170, v172, v115
    v_mul_f32 v172, v172, v114
    v_fmac_f32 v172, v180, v115
    v_fma_f32 v180, v180, v114, -v170
    v_mul_f32 v170, v173, v117
    v_mul_f32 v173, v173, v116
    v_fmac_f32 v173, v181, v117
    v_fma_f32 v181, v181, v116, -v170
    v_mul_f32 v170, v174, v119
    v_mul_f32 v174, v174, v118
    v_fmac_f32 v174, v182, v119
    v_fma_f32 v182, v182, v118, -v170
    v_mul_f32 v170, v175, v121
    v_mul_f32 v175, v175, v120
    v_fmac_f32 v175, v183, v121
    v_fma_f32 v183, v183, v120, -v170
    v_cvt_pk_f16_f32 v10, v172, v173
    v_cvt_pk_f16_f32 v11, v174, v175
    v_cvt_pk_f16_f32 v12, v180, v181
    v_cvt_pk_f16_f32 v13, v182, v183
    v_mul_f32 v170, v176, v123
    v_mul_f32 v176, v176, v122
    v_fmac_f32 v176, v184, v123
    v_fma_f32 v184, v184, v122, -v170
    v_mul_f32 v170, v177, v125
    v_mul_f32 v177, v177, v124
    v_fmac_f32 v177, v185, v125
    v_fma_f32 v185, v185, v124, -v170
    v_mul_f32 v170, v178, v127
    v_mul_f32 v178, v178, v126
    v_fmac_f32 v178, v186, v127
    v_fma_f32 v186, v186, v126, -v170
    v_mul_f32 v170, v179, v129
    v_mul_f32 v179, v179, v128
    v_fmac_f32 v179, v187, v129
    v_fma_f32 v187, v187, v128, -v170
    v_cvt_pk_f16_f32 v14, v176, v177
    v_cvt_pk_f16_f32 v15, v178, v179
    v_cvt_pk_f16_f32 v16, v184, v185
    v_cvt_pk_f16_f32 v17, v186, v187
    v_lshlrev_b32 v148, 16, v42
    v_and_b32 v149, 0xffff0000, v42
    v_mul_f32 v148, s33, v148
    v_mul_f32 v149, s33, v149
    v_lshlrev_b32 v150, 16, v43
    v_and_b32 v151, 0xffff0000, v43
    v_mul_f32 v150, s33, v150
    v_mul_f32 v151, s33, v151
    v_lshlrev_b32 v152, 16, v44
    v_and_b32 v153, 0xffff0000, v44
    v_mul_f32 v152, s33, v152
    v_mul_f32 v153, s33, v153
    v_lshlrev_b32 v154, 16, v45
    v_and_b32 v155, 0xffff0000, v45
    v_mul_f32 v154, s33, v154
    v_mul_f32 v155, s33, v155
    v_lshlrev_b32 v156, 16, v46
    v_and_b32 v157, 0xffff0000, v46
    v_mul_f32 v156, s33, v156
    v_mul_f32 v157, s33, v157
    v_lshlrev_b32 v158, 16, v47
    v_and_b32 v159, 0xffff0000, v47
    v_mul_f32 v158, s33, v158
    v_mul_f32 v159, s33, v159
    v_lshlrev_b32 v160, 16, v48
    v_and_b32 v161, 0xffff0000, v48
    v_mul_f32 v160, s33, v160
    v_mul_f32 v161, s33, v161
    v_lshlrev_b32 v162, 16, v49
    v_and_b32 v163, 0xffff0000, v49
    v_mul_f32 v162, s33, v162
    v_mul_f32 v163, s33, v163
    v_mfma_f32_16x16x32_f16 v[172:175], v[82:85], v[10:13], 0
    v_mfma_f32_16x16x32_f16 v[180:183], v[98:101], v[10:13], 0
    v_mfma_f32_16x16x32_f16 v[172:175], v[86:89], v[14:17], v[172:175]
    v_mfma_f32_16x16x32_f16 v[180:183], v[102:105], v[14:17], v[180:183]
    v_mfma_f32_16x16x32_f16 v[176:179], v[90:93], v[10:13], 0
    v_mfma_f32_16x16x32_f16 v[184:187], v[106:109], v[10:13], 0
    v_mfma_f32_16x16x32_f16 v[176:179], v[94:97], v[14:17], v[176:179]
    v_mfma_f32_16x16x32_f16 v[184:187], v[110:113], v[14:17], v[184:187]
    s_nop 7
    v_mul_f32 v170, v172, v149
    v_mul_f32 v172, v172, v148
    v_fma_f32 v172, -v180, v149, v172
    v_fma_f32 v180, v180, v148, v170
    v_mul_f32 v170, v173, v151
    v_mul_f32 v173, v173, v150
    v_fma_f32 v173, -v181, v151, v173
    v_fma_f32 v181, v181, v150, v170
    v_mul_f32 v170, v174, v153
    v_mul_f32 v174, v174, v152
    v_fma_f32 v174, -v182, v153, v174
    v_fma_f32 v182, v182, v152, v170
    v_mul_f32 v170, v175, v155
    v_mul_f32 v175, v175, v154
    v_fma_f32 v175, -v183, v155, v175
    v_fma_f32 v183, v183, v154, v170
    v_cvt_pk_f16_f32 v18, v172, v173
    v_cvt_pk_f16_f32 v19, v174, v175
    v_cvt_pk_f16_f32 v20, -v180, -v181
    v_cvt_pk_f16_f32 v21, -v182, -v183
    v_mul_f32 v170, v176, v157
    v_mul_f32 v176, v176, v156
    v_fma_f32 v176, -v184, v157, v176
    v_fma_f32 v184, v184, v156, v170
    v_mul_f32 v170, v177, v159
    v_mul_f32 v177, v177, v158
    v_fma_f32 v177, -v185, v159, v177
    v_fma_f32 v185, v185, v158, v170
    v_mul_f32 v170, v178, v161
    v_mul_f32 v178, v178, v160
    v_fma_f32 v178, -v186, v161, v178
    v_fma_f32 v186, v186, v160, v170
    v_mul_f32 v170, v179, v163
    v_mul_f32 v179, v179, v162
    v_fma_f32 v179, -v187, v163, v179
    v_fma_f32 v187, v187, v162, v170
    v_cvt_pk_f16_f32 v22, v176, v177
    v_cvt_pk_f16_f32 v23, v178, v179
    v_cvt_pk_f16_f32 v24, -v184, -v185
    v_cvt_pk_f16_f32 v25, -v186, -v187
    s_nop 1
    v_mfma_f32_16x16x32_f16 v[172:175], v[18:21], v[82:85], 0
    v_mfma_f32_16x16x32_f16 v[180:183], v[18:21], v[98:101], 0
    v_mfma_f32_16x16x32_f16 v[172:175], v[22:25], v[86:89], v[172:175]
    v_mfma_f32_16x16x32_f16 v[180:183], v[22:25], v[102:105], v[180:183]
    v_mfma_f32_16x16x32_f16 v[176:179], v[18:21], v[90:93], 0
    v_mfma_f32_16x16x32_f16 v[184:187], v[18:21], v[106:109], 0
    v_mfma_f32_16x16x32_f16 v[176:179], v[22:25], v[94:97], v[176:179]
    v_mfma_f32_16x16x32_f16 v[184:187], v[22:25], v[110:113], v[184:187]
    s_nop 7
    v_mul_f32 v170, v172, v131
    v_mul_f32 v172, v172, v130
    v_fmac_f32 v172, v180, v131
    v_fma_f32 v180, v180, v130, -v170
    v_mul_f32 v170, v173, v133
    v_mul_f32 v173, v173, v132
    v_fmac_f32 v173, v181, v133
    v_fma_f32 v181, v181, v132, -v170
    v_mul_f32 v170, v174, v135
    v_mul_f32 v174, v174, v134
    v_fmac_f32 v174, v182, v135
    v_fma_f32 v182, v182, v134, -v170
    v_mul_f32 v170, v175, v137
    v_mul_f32 v175, v175, v136
    v_fmac_f32 v175, v183, v137
    v_fma_f32 v183, v183, v136, -v170
    v_cvt_pk_f16_f32 v10, v172, v173
    v_cvt_pk_f16_f32 v11, v174, v175
    v_cvt_pk_f16_f32 v12, v180, v181
    v_cvt_pk_f16_f32 v13, v182, v183
    ds_write_b128 v2, v[10:13] offset:0
    v_mul_f32 v170, v176, v139
    v_mul_f32 v176, v176, v138
    v_fmac_f32 v176, v184, v139
    v_fma_f32 v184, v184, v138, -v170
    v_mul_f32 v170, v177, v141
    v_mul_f32 v177, v177, v140
    v_fmac_f32 v177, v185, v141
    v_fma_f32 v185, v185, v140, -v170
    v_mul_f32 v170, v178, v143
    v_mul_f32 v178, v178, v142
    v_fmac_f32 v178, v186, v143
    v_fma_f32 v186, v186, v142, -v170
    v_mul_f32 v170, v179, v145
    v_mul_f32 v179, v179, v144
    v_fmac_f32 v179, v187, v145
    v_fma_f32 v187, v187, v144, -v170
    v_cvt_pk_f16_f32 v14, v176, v177
    v_cvt_pk_f16_f32 v15, v178, v179
    v_cvt_pk_f16_f32 v16, v184, v185
    v_cvt_pk_f16_f32 v17, v186, v187
    ds_write_b128 v2, v[14:17] offset:4352
    s_waitcnt lgkmcnt(0)
    s_barrier
    ds_read_b128 v[10:13], v1 offset:0
    ds_read_b128 v[14:17], v1 offset:64
    ds_read_b128 v[18:21], v1 offset:128
    ds_read_b128 v[22:25], v1 offset:192
    ds_read_b128 v[26:29], v1 offset:4352
    ds_read_b128 v[30:33], v1 offset:4416
    ds_read_b128 v[34:37], v1 offset:4480
    ds_read_b128 v[38:41], v1 offset:4544
    s_waitcnt lgkmcnt(7)
    v_mfma_f32_16x16x32_f16 v[172:175], v[10:13], v[50:53], 0
    v_mfma_f32_16x16x32_f16 v[180:183], v[10:13], v[66:69], 0
    s_waitcnt lgkmcnt(6)
    v_mfma_f32_16x16x32_f16 v[172:175], v[14:17], v[54:57], v[172:175]
    v_mfma_f32_16x16x32_f16 v[180:183], v[14:17], v[70:73], v[180:183]
    s_waitcnt lgkmcnt(5)
    v_mfma_f32_16x16x32_f16 v[172:175], v[18:21], v[58:61], v[172:175]
    v_mfma_f32_16x16x32_f16 v[180:183], v[18:21], v[74:77], v[180:183]
    s_waitcnt lgkmcnt(4)
    v_mfma_f32_16x16x32_f16 v[172:175], v[22:25], v[62:65], v[172:175]
    v_mfma_f32_16x16x32_f16 v[180:183], v[22:25], v[78:81], v[180:183]
    s_waitcnt lgkmcnt(3)
    v_mfma_f32_16x16x32_f16 v[176:179], v[26:29], v[50:53], 0
    v_mfma_f32_16x16x32_f16 v[184:187], v[26:29], v[66:69], 0
    s_waitcnt lgkmcnt(2)
    v_mfma_f32_16x16x32_f16 v[176:179], v[30:33], v[54:57], v[176:179]
    v_mfma_f32_16x16x32_f16 v[184:187], v[30:33], v[70:73], v[184:187]
    s_waitcnt lgkmcnt(1)
    v_mfma_f32_16x16x32_f16 v[176:179], v[34:37], v[58:61], v[176:179]
    v_mfma_f32_16x16x32_f16 v[184:187], v[34:37], v[74:77], v[184:187]
    s_waitcnt lgkmcnt(0)
    v_mfma_f32_16x16x32_f16 v[176:179], v[38:41], v[62:65], v[176:179]
    v_mfma_f32_16x16x32_f16 v[184:187], v[38:41], v[78:81], v[184:187]
    s_nop 7
    v_mul_f32 v172, s15, v172
    v_mul_f32 v180, s15, v180
    v_cvt_pk_f16_f32 v172, v172, -v180
    v_mul_f32 v173, s15, v173
    v_mul_f32 v181, s15, v181
    v_cvt_pk_f16_f32 v173, v173, -v181
    v_mul_f32 v174, s15, v174
    v_mul_f32 v182, s15, v182
    v_cvt_pk_f16_f32 v174, v174, -v182
    v_mul_f32 v175, s15, v175
    v_mul_f32 v183, s15, v183
    v_cvt_pk_f16_f32 v175, v175, -v183
    buffer_store_dwordx4 v[172:175], v3, s[24:27], s3 offen offset:0
    v_mul_f32 v176, s15, v176
    v_mul_f32 v184, s15, v184
    v_cvt_pk_f16_f32 v176, v176, -v184
    v_mul_f32 v177, s15, v177
    v_mul_f32 v185, s15, v185
    v_cvt_pk_f16_f32 v177, v177, -v185
    v_mul_f32 v178, s15, v178
    v_mul_f32 v186, s15, v186
    v_cvt_pk_f16_f32 v178, v178, -v186
    v_mul_f32 v179, s15, v179
    v_mul_f32 v187, s15, v187
    v_cvt_pk_f16_f32 v179, v179, -v187
    buffer_store_dwordx4 v[176:179], v3, s[24:27], s3 offen offset:64
K2_END:
    s_endpgm
K2_PF:
    s_sub_u32 s3, s2, 296
    s_cmp_ge_u32 s3, 144
    s_cbranch_scc1 K2_END
    s_load_dwordx4 s[4:7], s[0:1], 40
    s_load_dwordx2 s[8:9], s[0:1], 56
    s_and_b32 s12, s3, 0xf0
    s_and_b32 s13, s3, 7
    s_lshl_b32 s13, s13, 1
    s_or_b32 s12, s12, s13
    s_bfe_u32 s13, s3, 0x10003
    s_or_b32 s12, s12, s13
    v_and_b32 v1, 7, v0
    v_lshrrev_b32 v2, 3, v0
    v_mul_u32_u24 v3, 9216, v2
    v_lshl_add_u32 v3, v1, 4, v3
    s_lshr_b32 s13, s12, 1
    s_lshl_b32 s13, s13, 7
    s_and_b32 s14, s12, 1
    s_mul_i32 s14, s14, 2654208
    s_add_u32 s13, s13, s14
    v_add_u32 v3, s13, v3
    v_lshlrev_b32 v4, 4, v0
    s_mul_i32 s12, s12, 36864
    s_waitcnt lgkmcnt(0)
    s_mov_b32 s16, s4
    s_mov_b32 s17, s5
    s_mov_b32 s18, 0x510000
    s_mov_b32 s19, 0x20000
    s_mov_b32 s20, s6
    s_mov_b32 s21, s7
    s_mov_b32 s22, 0x510000
    s_mov_b32 s23, 0x20000
    s_mov_b32 s24, s8
    s_mov_b32 s25, s9
    s_mov_b32 s26, 0x510000
    s_mov_b32 s27, 0x20000
    s_mov_b32 s3, 0
    buffer_load_dwordx4 v[44:47], v3, s[20:23], s3 offen
    s_mov_b32 s3, 294912
    buffer_load_dwordx4 v[48:51], v3, s[20:23], s3 offen
    s_mov_b32 s3, 589824
    buffer_load_dwordx4 v[52:55], v3, s[20:23], s3 offen
    s_mov_b32 s3, 884736
    buffer_load_dwordx4 v[56:59], v3, s[20:23], s3 offen
    s_mov_b32 s3, 1179648
    buffer_load_dwordx4 v[60:63], v3, s[20:23], s3 offen
    s_mov_b32 s3, 1474560
    buffer_load_dwordx4 v[64:67], v3, s[20:23], s3 offen
    s_mov_b32 s3, 1769472
    buffer_load_dwordx4 v[68:71], v3, s[20:23], s3 offen
    s_mov_b32 s3, 2064384
    buffer_load_dwordx4 v[72:75], v3, s[20:23], s3 offen
    s_mov_b32 s3, 2359296
    buffer_load_dwordx4 v[76:79], v3, s[20:23], s3 offen
    s_add_u32 s3, s12, 0
    buffer_load_dwordx4 v[80:83], v4, s[24:27], s3 offen
    s_add_u32 s3, s12, 4096
    buffer_load_dwordx4 v[84:87], v4, s[24:27], s3 offen
    s_add_u32 s3, s12, 8192
    buffer_load_dwordx4 v[88:91], v4, s[24:27], s3 offen
    s_add_u32 s3, s12, 12288
    buffer_load_dwordx4 v[92:95], v4, s[24:27], s3 offen
    s_add_u32 s3, s12, 16384
    buffer_load_dwordx4 v[96:99], v4, s[24:27], s3 offen
    s_add_u32 s3, s12, 20480
    buffer_load_dwordx4 v[100:103], v4, s[24:27], s3 offen
    s_add_u32 s3, s12, 24576
    buffer_load_dwordx4 v[80:83], v4, s[24:27], s3 offen
    s_add_u32 s3, s12, 28672
    buffer_load_dwordx4 v[84:87], v4, s[24:27], s3 offen
    s_add_u32 s3, s12, 32768
    buffer_load_dwordx4 v[88:91], v4, s[24:27], s3 offen
    s_waitcnt vmcnt(0)
    s_endpgm
.globl fc_kernel
.p2align 8
.type fc_kernel,@function
fc_kernel:
    s_cmp_ge_u32 s2, 256
    s_cbranch_scc1 MOE
    s_load_dwordx2 s[4:5], s[0:1], 0
    s_load_dwordx2 s[6:7], s[0:1], 32
    s_load_dwordx2 s[8:9], s[0:1], 64
    s_load_dwordx2 s[10:11], s[0:1], 80
    s_and_b32 s3, s2, 7
    s_lshl_b32 s3, s3, 5
    s_lshr_b32 s12, s2, 3
    s_add_u32 s3, s3, s12
    v_lshrrev_b32 v1, 5, v0
    v_and_b32 v2, 31, v0
    v_lshrrev_b32 v6, 6, v0
    v_and_b32 v7, 63, v0
    v_and_b32 v8, 15, v0
    v_readfirstlane_b32 s13, v6
    v_lshrrev_b32 v9, 4, v7
    s_lshl_b32 s12, s3, 3
    v_add_u32 v3, s12, v1
    v_mul_u32_u24 v3, 1152, v3
    v_lshl_add_u32 v3, v2, 1, v3
    v_lshlrev_b32 v4, 1, v2
    v_lshrrev_b32 v5, 1, v0
    v_lshlrev_b32 v5, 13, v5
    v_and_b32 v110, 1, v0
    v_lshl_add_u32 v5, v110, 4, v5
    s_lshl_b32 s14, s3, 5
    s_waitcnt lgkmcnt(0)
    s_mov_b32 s16, s4
    s_mov_b32 s17, s5
    s_mov_b32 s18, 0x240000
    s_mov_b32 s19, 0x20000
    s_mov_b32 s20, s6
    s_mov_b32 s21, s7
    s_mov_b32 s22, 0x480
    s_mov_b32 s23, 0x20000
    s_mov_b32 s24, s8
    s_mov_b32 s25, s9
    s_mov_b32 s26, 0x240000
    s_mov_b32 s27, 0x20000
    s_add_u32 s28, s10, 0x4a0000
    s_addc_u32 s29, s11, 0
    s_mov_b32 s30, 0x242000
    s_mov_b32 s31, 0x20000
    s_add_u32 s32, s10, 0x942000
    s_addc_u32 s33, s11, 0
    s_mov_b32 s34, 0x910
    s_mov_b32 s35, 0x20000
    s_add_u32 s36, s10, 0x6f0000
    s_addc_u32 s37, s11, 0
    s_mov_b32 s38, 0x240000
    s_mov_b32 s39, 0x20000
    s_add_u32 s40, s10, 0x94e000
    s_addc_u32 s41, s11, 0
    s_mov_b32 s42, 0x2000
    s_mov_b32 s43, 0x20000
    s_add_u32 s44, s10, 0x950000
    s_addc_u32 s45, s11, 0
    s_mov_b32 s46, 0x4000
    s_mov_b32 s47, 0x20000
    s_add_u32 s15, s14, 0
    buffer_load_dwordx4 v[10:13], v5, s[28:31], s15 offen
    s_add_u32 s15, s14, 1048576
    buffer_load_dwordx4 v[14:17], v5, s[28:31], s15 offen
    s_add_u32 s15, s14, 2097152
    buffer_load_dwordx4 v[18:21], v5, s[28:31], s15 offen
    v_mul_u32_u24 v124, 48, v7
    buffer_load_dwordx4 v[112:115], v124, s[32:35], 0 offen offset:0
    buffer_load_dwordx4 v[116:119], v124, s[32:35], 0 offen offset:16
    buffer_load_dwordx4 v[120:123], v124, s[32:35], 0 offen offset:32
    buffer_load_ushort v22, v3, s[16:19], 0 offen offset:0
    buffer_load_ushort v23, v3, s[16:19], 0 offen offset:64
    buffer_load_ushort v24, v3, s[16:19], 0 offen offset:128
    buffer_load_ushort v25, v3, s[16:19], 0 offen offset:192
    buffer_load_ushort v26, v3, s[16:19], 0 offen offset:256
    buffer_load_ushort v27, v3, s[16:19], 0 offen offset:320
    buffer_load_ushort v28, v3, s[16:19], 0 offen offset:384
    buffer_load_ushort v29, v3, s[16:19], 0 offen offset:448
    buffer_load_ushort v30, v3, s[16:19], 0 offen offset:512
    buffer_load_ushort v31, v3, s[16:19], 0 offen offset:576
    buffer_load_ushort v32, v3, s[16:19], 0 offen offset:640
    buffer_load_ushort v33, v3, s[16:19], 0 offen offset:704
    buffer_load_ushort v34, v3, s[16:19], 0 offen offset:768
    buffer_load_ushort v35, v3, s[16:19], 0 offen offset:832
    buffer_load_ushort v36, v3, s[16:19], 0 offen offset:896
    buffer_load_ushort v37, v3, s[16:19], 0 offen offset:960
    buffer_load_ushort v38, v3, s[16:19], 0 offen offset:1024
    buffer_load_ushort v39, v3, s[16:19], 0 offen offset:1088
    buffer_load_ushort v40, v4, s[20:23], 0 offen offset:0
    buffer_load_ushort v41, v4, s[20:23], 0 offen offset:64
    buffer_load_ushort v42, v4, s[20:23], 0 offen offset:128
    buffer_load_ushort v43, v4, s[20:23], 0 offen offset:192
    buffer_load_ushort v44, v4, s[20:23], 0 offen offset:256
    buffer_load_ushort v45, v4, s[20:23], 0 offen offset:320
    buffer_load_ushort v46, v4, s[20:23], 0 offen offset:384
    buffer_load_ushort v47, v4, s[20:23], 0 offen offset:448
    buffer_load_ushort v48, v4, s[20:23], 0 offen offset:512
    buffer_load_ushort v49, v4, s[20:23], 0 offen offset:576
    buffer_load_ushort v50, v4, s[20:23], 0 offen offset:640
    buffer_load_ushort v51, v4, s[20:23], 0 offen offset:704
    buffer_load_ushort v52, v4, s[20:23], 0 offen offset:768
    buffer_load_ushort v53, v4, s[20:23], 0 offen offset:832
    buffer_load_ushort v54, v4, s[20:23], 0 offen offset:896
    buffer_load_ushort v55, v4, s[20:23], 0 offen offset:960
    buffer_load_ushort v56, v4, s[20:23], 0 offen offset:1024
    buffer_load_ushort v57, v4, s[20:23], 0 offen offset:1088
    v_lshrrev_b32 v58, 7, v0
    v_mul_u32_u24 v58, 72, v58
    v_bfe_u32 v59, v0, 4, 3
    v_add_u32 v58, v58, v59
    v_mul_u32_u24 v58, 144, v58
    v_lshl_add_u32 v59, v8, 2, 64
    v_and_b32 v60, 0x8f, v0
    v_cmp_eq_u32 vcc, 0, v60
    v_mov_b32 v60, 0x80
    v_mov_b32 v61, 0
    v_cndmask_b32 v59, v59, v60, vcc
    v_add_u32 v58, v58, v59
    ds_write_b32 v58, v61
    v_lshrrev_b32 v64, 1, v0
    v_add_u32 v64, 0, v64
    v_min_u32 v64, 0x121, v64
    v_mul_u32_u24 v65, 3641, v64
    v_lshrrev_b32 v65, 16, v65
    v_mul_u32_u24 v66, 18, v65
    v_sub_u32 v66, v64, v66
    v_cmp_lt_u32 vcc, 9, v66
    v_sub_u32 v67, 18, v66
    v_sub_u32 v68, 31, v65
    v_cndmask_b32 v66, v66, v67, vcc
    v_cndmask_b32 v65, v65, v68, vcc
    v_mov_b32 v67, 0x80000000
    v_cndmask_b32 v61, 0, v67, vcc
    v_lshlrev_b32 v66, 1, v66
    v_add_u32 v66, v66, v110
    v_mul_u32_u24 v66, 576, v66
    v_lshl_add_u32 v58, v65, 2, v66
    v_lshrrev_b32 v64, 1, v0
    v_add_u32 v64, 128, v64
    v_min_u32 v64, 0x121, v64
    v_mul_u32_u24 v65, 3641, v64
    v_lshrrev_b32 v65, 16, v65
    v_mul_u32_u24 v66, 18, v65
    v_sub_u32 v66, v64, v66
    v_cmp_lt_u32 vcc, 9, v66
    v_sub_u32 v67, 18, v66
    v_sub_u32 v68, 31, v65
    v_cndmask_b32 v66, v66, v67, vcc
    v_cndmask_b32 v65, v65, v68, vcc
    v_mov_b32 v67, 0x80000000
    v_cndmask_b32 v62, 0, v67, vcc
    v_lshlrev_b32 v66, 1, v66
    v_add_u32 v66, v66, v110
    v_mul_u32_u24 v66, 576, v66
    v_lshl_add_u32 v59, v65, 2, v66
    v_lshrrev_b32 v64, 1, v0
    v_add_u32 v64, 256, v64
    v_min_u32 v64, 0x121, v64
    v_mul_u32_u24 v65, 3641, v64
    v_lshrrev_b32 v65, 16, v65
    v_mul_u32_u24 v66, 18, v65
    v_sub_u32 v66, v64, v66
    v_cmp_lt_u32 vcc, 9, v66
    v_sub_u32 v67, 18, v66
    v_sub_u32 v68, 31, v65
    v_cndmask_b32 v66, v66, v67, vcc
    v_cndmask_b32 v65, v65, v68, vcc
    v_mov_b32 v67, 0x80000000
    v_cndmask_b32 v63, 0, v67, vcc
    v_lshlrev_b32 v66, 1, v66
    v_add_u32 v66, v66, v110
    v_mul_u32_u24 v66, 576, v66
    v_lshl_add_u32 v60, v65, 2, v66
    v_cmp_lt_u32 vcc, 65, v0
    v_mov_b32 v64, 0x84
    s_nop 0
    v_cndmask_b32 v60, v60, v64, vcc
    v_lshrrev_b32 v64, 2, v8
    v_lshlrev_b32 v64, 1, v64
    v_bfe_u32 v65, v8, 1, 1
    v_add_u32 v64, v64, v65
    s_lshl_b32 s12, s13, 3
    v_add_u32 v64, s12, v64
    v_mul_u32_u24 v65, 0x8000, v65
    v_lshl_or_b32 v65, v65, 16, v65
    v_cvt_f32_u32 v64, v64
    v_mul_f32 v64, 0x3d000000, v64
    v_lshlrev_b32 v66, 2, v9
    v_cvt_f32_u32 v66, v66
    v_and_b32 v67, 1, v8
    v_cmp_eq_u32 s[48:49], 1, v67
    v_add_f32 v67, 0.0, v66
    v_mul_f32 v67, v67, v64
    v_cos_f32 v68, v67
    v_sin_f32 v69, v67
    s_nop 0
    v_mul_f32 v68, 0x3e3504f3, v68
    v_mul_f32 v69, 0x3e3504f3, v69
    v_cvt_pk_f16_f32 v78, v68, -v69
    v_cvt_pk_f16_f32 v79, v69, v68
    v_cndmask_b32 v70, v78, v79, s[48:49]
    v_xor_b32 v74, v65, v70
    v_add_f32 v67, 1.0, v66
    v_mul_f32 v67, v67, v64
    v_cos_f32 v68, v67
    v_sin_f32 v69, v67
    s_nop 0
    v_mul_f32 v68, 0x3e3504f3, v68
    v_mul_f32 v69, 0x3e3504f3, v69
    v_cvt_pk_f16_f32 v78, v68, -v69
    v_cvt_pk_f16_f32 v79, v69, v68
    v_cndmask_b32 v71, v78, v79, s[48:49]
    v_xor_b32 v75, v65, v71
    v_add_f32 v67, 2.0, v66
    v_mul_f32 v67, v67, v64
    v_cos_f32 v68, v67
    v_sin_f32 v69, v67
    s_nop 0
    v_mul_f32 v68, 0x3e3504f3, v68
    v_mul_f32 v69, 0x3e3504f3, v69
    v_cvt_pk_f16_f32 v78, v68, -v69
    v_cvt_pk_f16_f32 v79, v69, v68
    v_cndmask_b32 v72, v78, v79, s[48:49]
    v_xor_b32 v76, v65, v72
    v_add_f32 v67, 3.0, v66
    v_mul_f32 v67, v67, v64
    v_cos_f32 v68, v67
    v_sin_f32 v69, v67
    s_nop 0
    v_mul_f32 v68, 0x3e3504f3, v68
    v_mul_f32 v69, 0x3e3504f3, v69
    v_cvt_pk_f16_f32 v78, v68, -v69
    v_cvt_pk_f16_f32 v79, v69, v68
    v_cndmask_b32 v73, v78, v79, s[48:49]
    v_xor_b32 v77, v65, v73
    v_cvt_f32_u32 v64, v2
    v_mul_f32 v65, 0x3ae38e39, v64
    v_cos_f32 v80, v65
    v_sin_f32 v81, v65
    v_mul_f32 v65, 0x3b638e39, v64
    v_cos_f32 v82, v65
    v_sin_f32 v83, v65
    v_mul_f32 v65, 0x3baaaaab, v64
    v_cos_f32 v84, v65
    v_sin_f32 v85, v65
    v_mul_f32 v65, 0x3be38e39, v64
    v_cos_f32 v86, v65
    v_sin_f32 v87, v65
    v_mul_f32 v65, 0x3c0e38e4, v64
    v_cos_f32 v88, v65
    v_sin_f32 v89, v65
    v_mul_f32 v65, 0x3c2aaaab, v64
    v_cos_f32 v90, v65
    v_sin_f32 v91, v65
    v_mul_f32 v65, 0x3c471c72, v64
    v_cos_f32 v92, v65
    v_sin_f32 v93, v65
    v_mul_f32 v65, 0x3c638e39, v64
    v_cos_f32 v94, v65
    v_sin_f32 v95, v65
    v_mul_f32 v65, 0x3c800000, v64
    v_cos_f32 v96, v65
    v_sin_f32 v97, v65
    s_waitcnt vmcnt(39)
    v_xor_b32 v10, v61, v10
    ds_write_b32 v58, v10 offset:0
    v_xor_b32 v11, v61, v11
    ds_write_b32 v58, v11 offset:144
    v_xor_b32 v12, v61, v12
    ds_write_b32 v58, v12 offset:288
    v_xor_b32 v13, v61, v13
    ds_write_b32 v58, v13 offset:432
    v_xor_b32 v14, v62, v14
    ds_write_b32 v59, v14 offset:0
    v_xor_b32 v15, v62, v15
    ds_write_b32 v59, v15 offset:144
    v_xor_b32 v16, v62, v16
    ds_write_b32 v59, v16 offset:288
    v_xor_b32 v17, v62, v17
    ds_write_b32 v59, v17 offset:432
    v_xor_b32 v18, v63, v18
    ds_write_b32 v60, v18 offset:0
    v_xor_b32 v19, v63, v19
    ds_write_b32 v60, v19 offset:144
    v_xor_b32 v20, v63, v20
    ds_write_b32 v60, v20 offset:288
    v_xor_b32 v21, v63, v21
    ds_write_b32 v60, v21 offset:432
    v_mul_u32_u24 v58, 144, v8
    v_lshl_add_u32 v58, v9, 4, v58
    v_and_b32 v59, 7, v8
    v_lshlrev_b32 v59, 5, v59
    v_lshl_add_u32 v59, v9, 1, v59
    v_add_u32 v59, s12, v59
    v_mul_u32_u24 v59, 80, v59
    v_lshrrev_b32 v60, 3, v8
    v_lshl_add_u32 v59, v60, 3, v59
    v_add_u32 v59, 11520, v59
    v_mul_u32_u24 v60, 80, v0
    v_add_u32 v60, 11520, v60
    s_waitcnt lgkmcnt(0)
    s_barrier
    ds_read_b128 v[126:129], v58 offset:0
    ds_read_b128 v[130:133], v58 offset:64
    ds_read_b128 v[134:137], v58 offset:2304
    ds_read_b128 v[138:141], v58 offset:2368
    ds_read_b128 v[142:145], v58 offset:4608
    ds_read_b128 v[146:149], v58 offset:4672
    ds_read_b128 v[150:153], v58 offset:6912
    ds_read_b128 v[154:157], v58 offset:6976
    ds_read_b128 v[158:161], v58 offset:9216
    ds_read_b128 v[162:165], v58 offset:9280
    s_waitcnt vmcnt(36)
    v_max3_u32 v112, v112, v113, v114
    v_max3_u32 v112, v112, v115, v116
    v_max3_u32 v112, v112, v117, v118
    v_max3_u32 v112, v112, v119, v120
    v_max3_u32 v112, v112, v121, v122
    v_max_u32 v112, v112, v123
    s_nop 1
    v_max_u32_dpp v112, v112, v112 quad_perm:[1,0,3,2] row_mask:0xf bank_mask:0xf
    s_nop 1
    v_max_u32_dpp v112, v112, v112 quad_perm:[2,3,0,1] row_mask:0xf bank_mask:0xf
    s_nop 1
    v_max_u32_dpp v112, v112, v112 row_half_mirror row_mask:0xf bank_mask:0xf
    s_nop 1
    v_max_u32_dpp v112, v112, v112 row_mirror row_mask:0xf bank_mask:0xf
    ds_swizzle_b32 v113, v112 offset:0x401F
    s_waitcnt lgkmcnt(0)
    v_max_u32 v112, v112, v113
    s_nop 1
    v_readlane_b32 s50, v112, 0
    v_readlane_b32 s51, v112, 32
    s_nop 3
    s_max_u32 s50, s50, s51
    s_lshr_b32 s50, s50, 7
    s_max_u32 s50, s50, 1
    s_min_u32 s50, s50, 253
    v_mfma_f32_16x16x32_f16 v[166:169], v[70:73], v[126:129], 0
    v_mfma_f32_16x16x32_f16 v[166:169], v[74:77], v[130:133], v[166:169]
    v_mfma_f32_16x16x32_f16 v[170:173], v[70:73], v[134:137], 0
    v_mfma_f32_16x16x32_f16 v[170:173], v[74:77], v[138:141], v[170:173]
    v_mfma_f32_16x16x32_f16 v[174:177], v[70:73], v[142:145], 0
    v_mfma_f32_16x16x32_f16 v[174:177], v[74:77], v[146:149], v[174:177]
    v_mfma_f32_16x16x32_f16 v[178:181], v[70:73], v[150:153], 0
    v_mfma_f32_16x16x32_f16 v[178:181], v[74:77], v[154:157], v[178:181]
    v_mfma_f32_16x16x32_f16 v[182:185], v[70:73], v[158:161], 0
    v_mfma_f32_16x16x32_f16 v[182:185], v[74:77], v[162:165], v[182:185]
    s_lshl_b32 s50, s50, 23
    v_mov_b32 v64, s50
    v_mul_f32 v64, 0x3e715bef, v64
    v_add_f32 v65, v64, v64
    v_mul_f32 v80, v65, v80
    v_mul_f32 v81, v65, v81
    v_mul_f32 v82, v65, v82
    v_mul_f32 v83, v65, v83
    v_mul_f32 v84, v65, v84
    v_mul_f32 v85, v65, v85
    v_mul_f32 v86, v65, v86
    v_mul_f32 v87, v65, v87
    v_mul_f32 v88, v65, v88
    v_mul_f32 v89, v65, v89
    v_mul_f32 v90, v65, v90
    v_mul_f32 v91, v65, v91
    v_mul_f32 v92, v65, v92
    v_mul_f32 v93, v65, v93
    v_mul_f32 v94, v65, v94
    v_mul_f32 v95, v65, v95
    v_mul_f32 v96, v64, v96
    v_mul_f32 v97, v64, v97
    ds_write_b64 v59, v[166:167] offset:0
    ds_write_b64 v59, v[168:169] offset:80
    ds_write_b64 v59, v[170:171] offset:16
    ds_write_b64 v59, v[172:173] offset:96
    ds_write_b64 v59, v[174:175] offset:32
    ds_write_b64 v59, v[176:177] offset:112
    ds_write_b64 v59, v[178:179] offset:48
    ds_write_b64 v59, v[180:181] offset:128
    ds_write_b64 v59, v[182:183] offset:64
    ds_write_b64 v59, v[184:185] offset:144
    s_waitcnt lgkmcnt(0)
    s_barrier
    ds_read_b128 v[126:129], v60 offset:0
    ds_read_b128 v[130:133], v60 offset:16
    ds_read_b128 v[134:137], v60 offset:32
    ds_read_b128 v[138:141], v60 offset:48
    ds_read_b128 v[142:145], v60 offset:64
    s_waitcnt vmcnt(0)
    v_lshlrev_b32 v22, 16, v22
    v_lshlrev_b32 v40, 16, v40
    v_lshlrev_b32 v23, 16, v23
    v_lshlrev_b32 v41, 16, v41
    v_lshlrev_b32 v24, 16, v24
    v_lshlrev_b32 v42, 16, v42
    v_lshlrev_b32 v25, 16, v25
    v_lshlrev_b32 v43, 16, v43
    v_lshlrev_b32 v26, 16, v26
    v_lshlrev_b32 v44, 16, v44
    v_lshlrev_b32 v27, 16, v27
    v_lshlrev_b32 v45, 16, v45
    v_lshlrev_b32 v28, 16, v28
    v_lshlrev_b32 v46, 16, v46
    v_lshlrev_b32 v29, 16, v29
    v_lshlrev_b32 v47, 16, v47
    v_lshlrev_b32 v30, 16, v30
    v_lshlrev_b32 v48, 16, v48
    v_lshlrev_b32 v31, 16, v31
    v_lshlrev_b32 v49, 16, v49
    v_lshlrev_b32 v32, 16, v32
    v_lshlrev_b32 v50, 16, v50
    v_lshlrev_b32 v33, 16, v33
    v_lshlrev_b32 v51, 16, v51
    v_lshlrev_b32 v34, 16, v34
    v_lshlrev_b32 v52, 16, v52
    v_lshlrev_b32 v35, 16, v35
    v_lshlrev_b32 v53, 16, v53
    v_lshlrev_b32 v36, 16, v36
    v_lshlrev_b32 v54, 16, v54
    v_lshlrev_b32 v37, 16, v37
    v_lshlrev_b32 v55, 16, v55
    v_lshlrev_b32 v38, 16, v38
    v_lshlrev_b32 v56, 16, v56
    v_lshlrev_b32 v39, 16, v39
    v_lshlrev_b32 v57, 16, v57
    s_waitcnt lgkmcnt(0)
    v_mul_f32 v126, v64, v126
    v_mul_f32 v66, v128, v81
    v_mul_f32 v128, v128, v80
    v_fma_f32 v128, -v129, v81, v128
    v_fma_f32 v129, v129, v80, v66
    v_mul_f32 v66, v130, v83
    v_mul_f32 v130, v130, v82
    v_fma_f32 v130, -v131, v83, v130
    v_fma_f32 v131, v131, v82, v66
    v_mul_f32 v66, v132, v85
    v_mul_f32 v132, v132, v84
    v_fma_f32 v132, -v133, v85, v132
    v_fma_f32 v133, v133, v84, v66
    v_mul_f32 v66, v134, v87
    v_mul_f32 v134, v134, v86
    v_fma_f32 v134, -v135, v87, v134
    v_fma_f32 v135, v135, v86, v66
    v_mul_f32 v66, v136, v89
    v_mul_f32 v136, v136, v88
    v_fma_f32 v136, -v137, v89, v136
    v_fma_f32 v137, v137, v88, v66
    v_mul_f32 v66, v138, v91
    v_mul_f32 v138, v138, v90
    v_fma_f32 v138, -v139, v91, v138
    v_fma_f32 v139, v139, v90, v66
    v_mul_f32 v66, v140, v93
    v_mul_f32 v140, v140, v92
    v_fma_f32 v140, -v141, v93, v140
    v_fma_f32 v141, v141, v92, v66
    v_mul_f32 v66, v142, v95
    v_mul_f32 v142, v142, v94
    v_fma_f32 v142, -v143, v95, v142
    v_fma_f32 v143, v143, v94, v66
    v_mul_f32 v144, v144, v96
    v_fma_f32 v144, -v145, v97, v144
    v_fmamk_f32 v146, v130, 0x3f800000, v126
    v_fmac_f32 v146, 0x3f800000, v134
    v_fmac_f32 v146, 0x3f800000, v138
    v_fmac_f32 v146, 0x3f800000, v142
    v_mul_f32 v151, 0x3f800000, v144
    v_fmac_f32 v151, 0x3f800000, v128
    v_fmac_f32 v151, 0x3f800000, v132
    v_fmac_f32 v151, 0x3f800000, v136
    v_fmac_f32 v151, 0x3f800000, v140
    v_fmamk_f32 v147, v130, 0x3f441b7d, v126
    v_fmac_f32 v147, 0x3e31d0d4, v134
    v_fmac_f32 v147, 0xbf000000, v138
    v_fmac_f32 v147, 0xbf708fb2, v142
    v_mul_f32 v152, 0xbf800000, v144
    v_fmac_f32 v152, 0x3f708fb2, v128
    v_fmac_f32 v152, 0x3f000000, v132
    v_fmac_f32 v152, 0xbe31d0d4, v136
    v_fmac_f32 v152, 0xbf441b7d, v140
    v_fmamk_f32 v148, v130, 0x3e31d0d4, v126
    v_fmac_f32 v148, 0xbf708fb2, v134
    v_fmac_f32 v148, 0xbf000000, v138
    v_fmac_f32 v148, 0x3f441b7d, v142
    v_mul_f32 v153, 0x3f800000, v144
    v_fmac_f32 v153, 0x3f441b7d, v128
    v_fmac_f32 v153, 0xbf000000, v132
    v_fmac_f32 v153, 0xbf708fb2, v136
    v_fmac_f32 v153, 0x3e31d0d4, v140
    v_fmamk_f32 v149, v130, 0xbf000000, v126
    v_fmac_f32 v149, 0xbf000000, v134
    v_fmac_f32 v149, 0x3f800000, v138
    v_fmac_f32 v149, 0xbf000000, v142
    v_mul_f32 v154, 0xbf800000, v144
    v_fmac_f32 v154, 0x3f000000, v128
    v_fmac_f32 v154, 0xbf800000, v132
    v_fmac_f32 v154, 0x3f000000, v136
    v_fmac_f32 v154, 0x3f000000, v140
    v_fmamk_f32 v150, v130, 0xbf708fb2, v126
    v_fmac_f32 v150, 0x3f441b7d, v134
    v_fmac_f32 v150, 0xbf000000, v138
    v_fmac_f32 v150, 0x3e31d0d4, v142
    v_mul_f32 v155, 0x3f800000, v144
    v_fmac_f32 v155, 0x3e31d0d4, v128
    v_fmac_f32 v155, 0xbf000000, v132
    v_fmac_f32 v155, 0x3f441b7d, v136
    v_fmac_f32 v155, 0xbf708fb2, v140
    v_mul_f32 v156, 0x3f248dbb, v131
    v_fmac_f32 v156, 0x3f7c1c5c, v135
    v_fmac_f32 v156, 0x3f5db3d7, v139
    v_fmac_f32 v156, 0x3eaf1d44, v143
    v_mul_f32 v160, 0x3eaf1d44, v129
    v_fmac_f32 v160, 0x3f5db3d7, v133
    v_fmac_f32 v160, 0x3f7c1c5c, v137
    v_fmac_f32 v160, 0x3f248dbb, v141
    v_mul_f32 v157, 0x3f7c1c5c, v131
    v_fmac_f32 v157, 0x3eaf1d44, v135
    v_fmac_f32 v157, 0xbf5db3d7, v139
    v_fmac_f32 v157, 0xbf248dbb, v143
    v_mul_f32 v161, 0x3f248dbb, v129
    v_fmac_f32 v161, 0x3f5db3d7, v133
    v_fmac_f32 v161, 0xbeaf1d44, v137
    v_fmac_f32 v161, 0xbf7c1c5c, v141
    v_mul_f32 v158, 0x3f5db3d7, v131
    v_fmac_f32 v158, 0xbf5db3d7, v135
    v_fmac_f32 v158, 0xa58d3132, v139
    v_fmac_f32 v158, 0x3f5db3d7, v143
    v_mul_f32 v162, 0x3f5db3d7, v129
    v_fmac_f32 v162, 0x250d3132, v133
    v_fmac_f32 v162, 0xbf5db3d7, v137
    v_fmac_f32 v162, 0x3f5db3d7, v141
    v_mul_f32 v159, 0x3eaf1d44, v131
    v_fmac_f32 v159, 0xbf248dbb, v135
    v_fmac_f32 v159, 0x3f5db3d7, v139
    v_fmac_f32 v159, 0xbf7c1c5c, v143
    v_mul_f32 v163, 0x3f7c1c5c, v129
    v_fmac_f32 v163, 0xbf5db3d7, v133
    v_fmac_f32 v163, 0x3f248dbb, v137
    v_fmac_f32 v163, 0xbeaf1d44, v141
    v_add_f32 v166, v146, v151
    v_sub_f32 v175, v146, v151
    v_add_f32 v66, v147, v152
    v_sub_f32 v67, v147, v152
    v_add_f32 v68, v160, v156
    v_sub_f32 v69, v160, v156
    v_sub_f32 v167, v66, v68
    v_add_f32 v183, v66, v68
    v_sub_f32 v174, v67, v69
    v_add_f32 v176, v67, v69
    v_add_f32 v66, v148, v153
    v_sub_f32 v67, v148, v153
    v_add_f32 v68, v161, v157
    v_sub_f32 v69, v161, v157
    v_sub_f32 v168, v66, v68
    v_add_f32 v182, v66, v68
    v_sub_f32 v173, v67, v69
    v_add_f32 v177, v67, v69
    v_add_f32 v66, v149, v154
    v_sub_f32 v67, v149, v154
    v_add_f32 v68, v162, v158
    v_sub_f32 v69, v162, v158
    v_sub_f32 v169, v66, v68
    v_add_f32 v181, v66, v68
    v_sub_f32 v172, v67, v69
    v_add_f32 v178, v67, v69
    v_add_f32 v66, v150, v155
    v_sub_f32 v67, v150, v155
    v_add_f32 v68, v163, v159
    v_sub_f32 v69, v163, v159
    v_sub_f32 v170, v66, v68
    v_add_f32 v180, v66, v68
    v_sub_f32 v171, v67, v69
    v_add_f32 v179, v67, v69
    v_mul_u32_u24 v4, 1152, v1
    v_lshl_add_u32 v4, v2, 1, v4
    v_cvt_pk_bf16_f32 v167, v166, v167
    v_lshlrev_b32 v166, 16, v167
    v_and_b32 v167, 0xffff0000, v167
    v_add_f32 v22, v22, v166
    v_add_f32 v23, v23, v167
    v_cvt_pk_bf16_f32 v23, v22, v23
    v_lshlrev_b32 v22, 16, v23
    v_and_b32 v23, 0xffff0000, v23
    ds_write_b16_d16_hi v4, v22 offset:0
    ds_write_b16_d16_hi v4, v23 offset:64
    v_cvt_pk_bf16_f32 v169, v168, v169
    v_lshlrev_b32 v168, 16, v169
    v_and_b32 v169, 0xffff0000, v169
    v_add_f32 v24, v24, v168
    v_add_f32 v25, v25, v169
    v_cvt_pk_bf16_f32 v25, v24, v25
    v_lshlrev_b32 v24, 16, v25
    v_and_b32 v25, 0xffff0000, v25
    ds_write_b16_d16_hi v4, v24 offset:128
    ds_write_b16_d16_hi v4, v25 offset:192
    v_cvt_pk_bf16_f32 v171, v170, v171
    v_lshlrev_b32 v170, 16, v171
    v_and_b32 v171, 0xffff0000, v171
    v_add_f32 v26, v26, v170
    v_add_f32 v27, v27, v171
    v_cvt_pk_bf16_f32 v27, v26, v27
    v_lshlrev_b32 v26, 16, v27
    v_and_b32 v27, 0xffff0000, v27
    ds_write_b16_d16_hi v4, v26 offset:256
    ds_write_b16_d16_hi v4, v27 offset:320
    v_cvt_pk_bf16_f32 v173, v172, v173
    v_lshlrev_b32 v172, 16, v173
    v_and_b32 v173, 0xffff0000, v173
    v_add_f32 v28, v28, v172
    v_add_f32 v29, v29, v173
    v_cvt_pk_bf16_f32 v29, v28, v29
    v_lshlrev_b32 v28, 16, v29
    v_and_b32 v29, 0xffff0000, v29
    ds_write_b16_d16_hi v4, v28 offset:384
    ds_write_b16_d16_hi v4, v29 offset:448
    v_cvt_pk_bf16_f32 v175, v174, v175
    v_lshlrev_b32 v174, 16, v175
    v_and_b32 v175, 0xffff0000, v175
    v_add_f32 v30, v30, v174
    v_add_f32 v31, v31, v175
    v_cvt_pk_bf16_f32 v31, v30, v31
    v_lshlrev_b32 v30, 16, v31
    v_and_b32 v31, 0xffff0000, v31
    ds_write_b16_d16_hi v4, v30 offset:512
    ds_write_b16_d16_hi v4, v31 offset:576
    v_cvt_pk_bf16_f32 v177, v176, v177
    v_lshlrev_b32 v176, 16, v177
    v_and_b32 v177, 0xffff0000, v177
    v_add_f32 v32, v32, v176
    v_add_f32 v33, v33, v177
    v_cvt_pk_bf16_f32 v33, v32, v33
    v_lshlrev_b32 v32, 16, v33
    v_and_b32 v33, 0xffff0000, v33
    ds_write_b16_d16_hi v4, v32 offset:640
    ds_write_b16_d16_hi v4, v33 offset:704
    v_cvt_pk_bf16_f32 v179, v178, v179
    v_lshlrev_b32 v178, 16, v179
    v_and_b32 v179, 0xffff0000, v179
    v_add_f32 v34, v34, v178
    v_add_f32 v35, v35, v179
    v_cvt_pk_bf16_f32 v35, v34, v35
    v_lshlrev_b32 v34, 16, v35
    v_and_b32 v35, 0xffff0000, v35
    ds_write_b16_d16_hi v4, v34 offset:768
    ds_write_b16_d16_hi v4, v35 offset:832
    v_cvt_pk_bf16_f32 v181, v180, v181
    v_lshlrev_b32 v180, 16, v181
    v_and_b32 v181, 0xffff0000, v181
    v_add_f32 v36, v36, v180
    v_add_f32 v37, v37, v181
    v_cvt_pk_bf16_f32 v37, v36, v37
    v_lshlrev_b32 v36, 16, v37
    v_and_b32 v37, 0xffff0000, v37
    ds_write_b16_d16_hi v4, v36 offset:896
    ds_write_b16_d16_hi v4, v37 offset:960
    v_cvt_pk_bf16_f32 v183, v182, v183
    v_lshlrev_b32 v182, 16, v183
    v_and_b32 v183, 0xffff0000, v183
    v_add_f32 v38, v38, v182
    v_add_f32 v39, v39, v183
    v_cvt_pk_bf16_f32 v39, v38, v39
    v_lshlrev_b32 v38, 16, v39
    v_and_b32 v39, 0xffff0000, v39
    ds_write_b16_d16_hi v4, v38 offset:1024
    ds_write_b16_d16_hi v4, v39 offset:1088
    v_add_f32 v70, v22, v23
    v_add_f32 v70, v70, v24
    v_add_f32 v70, v70, v25
    v_add_f32 v70, v70, v26
    v_add_f32 v70, v70, v27
    v_add_f32 v70, v70, v28
    v_add_f32 v70, v70, v29
    v_add_f32 v70, v70, v30
    v_add_f32 v70, v70, v31
    v_add_f32 v70, v70, v32
    v_add_f32 v70, v70, v33
    v_add_f32 v70, v70, v34
    v_add_f32 v70, v70, v35
    v_add_f32 v70, v70, v36
    v_add_f32 v70, v70, v37
    v_add_f32 v70, v70, v38
    v_add_f32 v70, v70, v39
    s_nop 1
    v_add_f32_dpp v70, v70, v70 quad_perm:[1,0,3,2] row_mask:0xf bank_mask:0xf
    s_nop 1
    v_add_f32_dpp v70, v70, v70 quad_perm:[2,3,0,1] row_mask:0xf bank_mask:0xf
    s_nop 1
    v_add_f32_dpp v70, v70, v70 row_half_mirror row_mask:0xf bank_mask:0xf
    s_nop 1
    v_add_f32_dpp v70, v70, v70 row_mirror row_mask:0xf bank_mask:0xf
    ds_swizzle_b32 v72, v70 offset:0x401F
    s_waitcnt lgkmcnt(0)
    v_add_f32 v70, v70, v72
    v_mul_f32 v70, 0x3ae38e39, v70
    v_sub_f32 v73, v22, v70
    v_mul_f32 v71, v73, v73
    v_sub_f32 v73, v23, v70
    v_fmac_f32 v71, v73, v73
    v_sub_f32 v73, v24, v70
    v_fmac_f32 v71, v73, v73
    v_sub_f32 v73, v25, v70
    v_fmac_f32 v71, v73, v73
    v_sub_f32 v73, v26, v70
    v_fmac_f32 v71, v73, v73
    v_sub_f32 v73, v27, v70
    v_fmac_f32 v71, v73, v73
    v_sub_f32 v73, v28, v70
    v_fmac_f32 v71, v73, v73
    v_sub_f32 v73, v29, v70
    v_fmac_f32 v71, v73, v73
    v_sub_f32 v73, v30, v70
    v_fmac_f32 v71, v73, v73
    v_sub_f32 v73, v31, v70
    v_fmac_f32 v71, v73, v73
    v_sub_f32 v73, v32, v70
    v_fmac_f32 v71, v73, v73
    v_sub_f32 v73, v33, v70
    v_fmac_f32 v71, v73, v73
    v_sub_f32 v73, v34, v70
    v_fmac_f32 v71, v73, v73
    v_sub_f32 v73, v35, v70
    v_fmac_f32 v71, v73, v73
    v_sub_f32 v73, v36, v70
    v_fmac_f32 v71, v73, v73
    v_sub_f32 v73, v37, v70
    v_fmac_f32 v71, v73, v73
    v_sub_f32 v73, v38, v70
    v_fmac_f32 v71, v73, v73
    v_sub_f32 v73, v39, v70
    v_fmac_f32 v71, v73, v73
    s_nop 1
    v_add_f32_dpp v71, v71, v71 quad_perm:[1,0,3,2] row_mask:0xf bank_mask:0xf
    s_nop 1
    v_add_f32_dpp v71, v71, v71 quad_perm:[2,3,0,1] row_mask:0xf bank_mask:0xf
    s_nop 1
    v_add_f32_dpp v71, v71, v71 row_half_mirror row_mask:0xf bank_mask:0xf
    s_nop 1
    v_add_f32_dpp v71, v71, v71 row_mirror row_mask:0xf bank_mask:0xf
    ds_swizzle_b32 v72, v71 offset:0x401F
    s_waitcnt lgkmcnt(0)
    v_add_f32 v71, v71, v72
    v_mul_f32 v71, 0x3ae38e39, v71
    v_cvt_pk_bf16_f32 v71, v70, v71
    v_lshlrev_b32 v70, 16, v71
    v_and_b32 v71, 0xffff0000, v71
    v_add_f32 v71, 0x3727c5ac, v71
    v_cvt_pk_bf16_f32 v71, v71, v71
    v_lshlrev_b32 v71, 16, v71
    v_sqrt_f32 v71, v71
    s_nop 0
    v_cvt_pk_bf16_f32 v71, v71, v71
    v_lshlrev_b32 v71, 16, v71
    v_rcp_f32 v71, v71
    s_nop 0
    v_sub_f32 v166, v22, v70
    v_sub_f32 v167, v23, v70
    v_cvt_pk_bf16_f32 v167, v166, v167
    v_lshlrev_b32 v166, 16, v167
    v_and_b32 v167, 0xffff0000, v167
    v_mul_f32 v166, v166, v71
    v_mul_f32 v167, v167, v71
    v_cvt_pk_bf16_f32 v167, v166, v167
    v_lshlrev_b32 v166, 16, v167
    v_and_b32 v167, 0xffff0000, v167
    v_sub_f32 v168, v24, v70
    v_sub_f32 v169, v25, v70
    v_cvt_pk_bf16_f32 v169, v168, v169
    v_lshlrev_b32 v168, 16, v169
    v_and_b32 v169, 0xffff0000, v169
    v_mul_f32 v168, v168, v71
    v_mul_f32 v169, v169, v71
    v_cvt_pk_bf16_f32 v169, v168, v169
    v_lshlrev_b32 v168, 16, v169
    v_and_b32 v169, 0xffff0000, v169
    v_sub_f32 v170, v26, v70
    v_sub_f32 v171, v27, v70
    v_cvt_pk_bf16_f32 v171, v170, v171
    v_lshlrev_b32 v170, 16, v171
    v_and_b32 v171, 0xffff0000, v171
    v_mul_f32 v170, v170, v71
    v_mul_f32 v171, v171, v71
    v_cvt_pk_bf16_f32 v171, v170, v171
    v_lshlrev_b32 v170, 16, v171
    v_and_b32 v171, 0xffff0000, v171
    v_sub_f32 v172, v28, v70
    v_sub_f32 v173, v29, v70
    v_cvt_pk_bf16_f32 v173, v172, v173
    v_lshlrev_b32 v172, 16, v173
    v_and_b32 v173, 0xffff0000, v173
    v_mul_f32 v172, v172, v71
    v_mul_f32 v173, v173, v71
    v_cvt_pk_bf16_f32 v173, v172, v173
    v_lshlrev_b32 v172, 16, v173
    v_and_b32 v173, 0xffff0000, v173
    v_sub_f32 v174, v30, v70
    v_sub_f32 v175, v31, v70
    v_cvt_pk_bf16_f32 v175, v174, v175
    v_lshlrev_b32 v174, 16, v175
    v_and_b32 v175, 0xffff0000, v175
    v_mul_f32 v174, v174, v71
    v_mul_f32 v175, v175, v71
    v_cvt_pk_bf16_f32 v175, v174, v175
    v_lshlrev_b32 v174, 16, v175
    v_and_b32 v175, 0xffff0000, v175
    v_sub_f32 v176, v32, v70
    v_sub_f32 v177, v33, v70
    v_cvt_pk_bf16_f32 v177, v176, v177
    v_lshlrev_b32 v176, 16, v177
    v_and_b32 v177, 0xffff0000, v177
    v_mul_f32 v176, v176, v71
    v_mul_f32 v177, v177, v71
    v_cvt_pk_bf16_f32 v177, v176, v177
    v_lshlrev_b32 v176, 16, v177
    v_and_b32 v177, 0xffff0000, v177
    v_sub_f32 v178, v34, v70
    v_sub_f32 v179, v35, v70
    v_cvt_pk_bf16_f32 v179, v178, v179
    v_lshlrev_b32 v178, 16, v179
    v_and_b32 v179, 0xffff0000, v179
    v_mul_f32 v178, v178, v71
    v_mul_f32 v179, v179, v71
    v_cvt_pk_bf16_f32 v179, v178, v179
    v_lshlrev_b32 v178, 16, v179
    v_and_b32 v179, 0xffff0000, v179
    v_sub_f32 v180, v36, v70
    v_sub_f32 v181, v37, v70
    v_cvt_pk_bf16_f32 v181, v180, v181
    v_lshlrev_b32 v180, 16, v181
    v_and_b32 v181, 0xffff0000, v181
    v_mul_f32 v180, v180, v71
    v_mul_f32 v181, v181, v71
    v_cvt_pk_bf16_f32 v181, v180, v181
    v_lshlrev_b32 v180, 16, v181
    v_and_b32 v181, 0xffff0000, v181
    v_sub_f32 v182, v38, v70
    v_sub_f32 v183, v39, v70
    v_cvt_pk_bf16_f32 v183, v182, v183
    v_lshlrev_b32 v182, 16, v183
    v_and_b32 v183, 0xffff0000, v183
    v_mul_f32 v182, v182, v71
    v_mul_f32 v183, v183, v71
    v_cvt_pk_bf16_f32 v183, v182, v183
    v_lshlrev_b32 v182, 16, v183
    v_and_b32 v183, 0xffff0000, v183
    v_mul_f32 v74, v166, v40
    v_fmac_f32 v74, v167, v41
    v_fmac_f32 v74, v168, v42
    v_fmac_f32 v74, v169, v43
    v_fmac_f32 v74, v170, v44
    v_fmac_f32 v74, v171, v45
    v_fmac_f32 v74, v172, v46
    v_fmac_f32 v74, v173, v47
    v_fmac_f32 v74, v174, v48
    v_fmac_f32 v74, v175, v49
    v_fmac_f32 v74, v176, v50
    v_fmac_f32 v74, v177, v51
    v_fmac_f32 v74, v178, v52
    v_fmac_f32 v74, v179, v53
    v_fmac_f32 v74, v180, v54
    v_fmac_f32 v74, v181, v55
    v_fmac_f32 v74, v182, v56
    v_fmac_f32 v74, v183, v57
    v_add_f32 v166, v166, v22
    v_add_f32 v167, v167, v23
    v_cvt_pk_bf16_f32 v166, v166, v167
    ds_write_b16 v4, v166 offset:32000
    ds_write_b16_d16_hi v4, v166 offset:32064
    v_add_f32 v168, v168, v24
    v_add_f32 v169, v169, v25
    v_cvt_pk_bf16_f32 v168, v168, v169
    ds_write_b16 v4, v168 offset:32128
    ds_write_b16_d16_hi v4, v168 offset:32192
    v_add_f32 v170, v170, v26
    v_add_f32 v171, v171, v27
    v_cvt_pk_bf16_f32 v170, v170, v171
    ds_write_b16 v4, v170 offset:32256
    ds_write_b16_d16_hi v4, v170 offset:32320
    v_add_f32 v172, v172, v28
    v_add_f32 v173, v173, v29
    v_cvt_pk_bf16_f32 v172, v172, v173
    ds_write_b16 v4, v172 offset:32384
    ds_write_b16_d16_hi v4, v172 offset:32448
    v_add_f32 v174, v174, v30
    v_add_f32 v175, v175, v31
    v_cvt_pk_bf16_f32 v174, v174, v175
    ds_write_b16 v4, v174 offset:32512
    ds_write_b16_d16_hi v4, v174 offset:32576
    v_add_f32 v176, v176, v32
    v_add_f32 v177, v177, v33
    v_cvt_pk_bf16_f32 v176, v176, v177
    ds_write_b16 v4, v176 offset:32640
    ds_write_b16_d16_hi v4, v176 offset:32704
    v_add_f32 v178, v178, v34
    v_add_f32 v179, v179, v35
    v_cvt_pk_bf16_f32 v178, v178, v179
    ds_write_b16 v4, v178 offset:32768
    ds_write_b16_d16_hi v4, v178 offset:32832
    v_add_f32 v180, v180, v36
    v_add_f32 v181, v181, v37
    v_cvt_pk_bf16_f32 v180, v180, v181
    ds_write_b16 v4, v180 offset:32896
    ds_write_b16_d16_hi v4, v180 offset:32960
    v_add_f32 v182, v182, v38
    v_add_f32 v183, v183, v39
    v_cvt_pk_bf16_f32 v182, v182, v183
    ds_write_b16 v4, v182 offset:33024
    ds_write_b16_d16_hi v4, v182 offset:33088
    s_nop 1
    v_add_f32_dpp v74, v74, v74 quad_perm:[1,0,3,2] row_mask:0xf bank_mask:0xf
    s_nop 1
    v_add_f32_dpp v74, v74, v74 quad_perm:[2,3,0,1] row_mask:0xf bank_mask:0xf
    s_nop 1
    v_add_f32_dpp v74, v74, v74 row_half_mirror row_mask:0xf bank_mask:0xf
    s_nop 1
    v_add_f32_dpp v74, v74, v74 row_mirror row_mask:0xf bank_mask:0xf
    ds_swizzle_b32 v72, v74 offset:0x401F
    s_waitcnt lgkmcnt(0)
    v_add_f32 v74, v74, v72
    v_cvt_pk_bf16_f32 v74, v74, v74
    v_and_b32 v74, 0xffff0000, v74
    v_ashrrev_i32 v75, 31, v74
    v_or_b32 v75, 0x80000000, v75
    v_xor_b32 v74, v74, v75
    v_and_b32 v74, 0xffff0000, v74
    s_lshl_b32 s12, s3, 3
    v_add_u32 v75, s12, v1
    v_sub_u32 v76, 0xffff, v75
    v_or_b32 v74, v74, v76
    v_lshlrev_b32 v76, 2, v75
    v_lshlrev_b32 v77, 3, v75
    v_lshlrev_b32 v4, 4, v0
    v_mov_b32 v5, 0x7fff0000
    v_cmp_lt_u32 vcc, 63, v0
    s_mul_i32 s12, s3, 9216
    s_add_u32 s13, s12, 0x1000
    v_add_u32 v6, 0x1000, v4
    v_cndmask_b32 v5, v6, v5, vcc
    v_cmp_eq_u32 vcc, 0, v2
    s_and_saveexec_b64 s[14:15], vcc
    buffer_store_dword v74, v76, s[40:43], 0 offen sc1
    s_mov_b64 exec, s[14:15]
    s_waitcnt lgkmcnt(0)
    s_barrier
    ds_read_b128 v[10:13], v4 offset:0
    ds_read_b128 v[14:17], v4 offset:32000
    ds_read_b128 v[18:21], v4 offset:4096
    ds_read_b128 v[22:25], v4 offset:36096
    ds_read_b128 v[26:29], v4 offset:8192
    ds_read_b128 v[30:33], v4 offset:40192
    s_waitcnt lgkmcnt(5)
    buffer_store_dwordx4 v[10:13], v4, s[36:39], s12 offen sc1
    s_waitcnt lgkmcnt(4)
    buffer_store_dwordx4 v[14:17], v4, s[24:27], s12 offen sc1
    s_waitcnt lgkmcnt(3)
    buffer_store_dwordx4 v[18:21], v4, s[36:39], s13 offen sc1
    s_waitcnt lgkmcnt(2)
    buffer_store_dwordx4 v[22:25], v4, s[24:27], s13 offen sc1
    s_waitcnt lgkmcnt(1)
    buffer_store_dwordx4 v[26:29], v5, s[36:39], s13 offen sc1
    s_waitcnt lgkmcnt(0)
    buffer_store_dwordx4 v[30:33], v5, s[24:27], s13 offen sc1
    v_or_b32 v70, 1, v70
    s_waitcnt vmcnt(0)
    s_barrier
    v_cmp_eq_u32 vcc, 0, v2
    s_and_saveexec_b64 s[14:15], vcc
    buffer_store_dwordx2 v[70:71], v77, s[44:47], 0 offen sc1
K3_DONE:
    s_endpgm
MOE:
    s_sub_u32 s61, s2, 256
    s_cmp_ge_u32 s61, 144
    s_cbranch_scc1 K4_END
    s_load_dwordx4 s[4:7], s[0:1], 40
    s_load_dwordx4 s[8:11], s[0:1], 56
    s_load_dwordx4 s[12:15], s[0:1], 72
    s_and_b32 s60, s61, 0xf0
    s_and_b32 s3, s61, 7
    s_lshl_b32 s3, s3, 1
    s_or_b32 s60, s60, s3
    s_bfe_u32 s3, s61, 0x10003
    s_or_b32 s60, s60, s3
    v_and_b32 v7, 63, v0
    v_lshrrev_b32 v6, 6, v0
    v_and_b32 v8, 15, v0
    v_readfirstlane_b32 s62, v6
    v_lshrrev_b32 v9, 4, v7
    v_mul_u32_u24 v3, 73728, v9
    v_lshl_add_u32 v3, v8, 2, v3
    s_lshl_b32 s3, s60, 6
    v_add_u32 v3, s3, v3
    s_cmp_ge_u32 s62, 2
    s_cselect_b32 s34, 0x7fff0000, 0
    v_add_u32 v5, s34, v3
    s_mul_i32 s63, s60, 36864
    s_add_u32 s35, s63, 4608
    v_mul_u32_u24 v4, 9216, v9
    s_lshl_b32 s3, s62, 5
    v_lshl_add_u32 v6, v8, 1, v4
    v_add_u32 v6, s3, v6
    v_add_u32 v6, 0x400, v6
    v_lshl_add_u32 v4, v8, 4, v4
    s_lshl_b32 s3, s62, 8
    v_add_u32 v4, s3, v4
    s_mul_i32 s34, s62, 294912
    s_mov_b32 s32, 0x05040100
    s_mov_b32 s33, 0x07060302
    s_waitcnt lgkmcnt(0)
    s_mov_b32 s16, s4
    s_mov_b32 s17, s5
    s_mov_b32 s18, 0x510000
    s_mov_b32 s19, 0x20000
    s_mov_b32 s20, s6
    s_mov_b32 s21, s7
    s_mov_b32 s22, 0x510000
    s_mov_b32 s23, 0x20000
    s_mov_b32 s24, s8
    s_mov_b32 s25, s9
    s_mov_b32 s26, 0x510000
    s_mov_b32 s27, 0x20000
    s_mov_b32 s28, s10
    s_mov_b32 s29, s11
    s_mov_b32 s30, 0x240000
    s_mov_b32 s31, 0x20000
    s_add_u32 s36, s14, 0x94e000
    s_addc_u32 s37, s15, 0
    s_mov_b32 s38, 0x2000
    s_mov_b32 s39, 0x20000
    s_add_u32 s40, s14, 0x6f0000
    s_addc_u32 s41, s15, 0
    s_mov_b32 s42, 0x240000
    s_mov_b32 s43, 0x20000
    s_add_u32 s44, s14, 0xb00000
    s_addc_u32 s45, s15, 0
    s_mov_b32 s46, 0xa2000
    s_mov_b32 s47, 0x20000
    s_add_u32 s48, s14, 0x950000
    s_addc_u32 s49, s15, 0
    s_mov_b32 s50, 0x4000
    s_mov_b32 s51, 0x20000
    s_add_u32 s3, s34, 0
    buffer_load_dword v14, v3, s[16:19], s3 offen
    buffer_load_dword v22, v3, s[20:23], s3 offen
    s_add_u32 s3, s34, 9216
    buffer_load_dword v18, v3, s[16:19], s3 offen
    buffer_load_dword v26, v3, s[20:23], s3 offen
    s_add_u32 s3, s34, 18432
    buffer_load_dword v15, v3, s[16:19], s3 offen
    buffer_load_dword v23, v3, s[20:23], s3 offen
    s_add_u32 s3, s34, 27648
    buffer_load_dword v19, v3, s[16:19], s3 offen
    buffer_load_dword v27, v3, s[20:23], s3 offen
    s_add_u32 s3, s34, 36864
    buffer_load_dword v16, v3, s[16:19], s3 offen
    buffer_load_dword v24, v3, s[20:23], s3 offen
    s_add_u32 s3, s34, 46080
    buffer_load_dword v20, v3, s[16:19], s3 offen
    buffer_load_dword v28, v3, s[20:23], s3 offen
    s_add_u32 s3, s34, 55296
    buffer_load_dword v17, v3, s[16:19], s3 offen
    buffer_load_dword v25, v3, s[20:23], s3 offen
    s_add_u32 s3, s34, 64512
    buffer_load_dword v21, v3, s[16:19], s3 offen
    buffer_load_dword v29, v3, s[20:23], s3 offen
    s_add_u32 s3, s34, 1179648
    buffer_load_dword v30, v3, s[16:19], s3 offen
    buffer_load_dword v38, v3, s[20:23], s3 offen
    s_add_u32 s3, s34, 1188864
    buffer_load_dword v34, v3, s[16:19], s3 offen
    buffer_load_dword v42, v3, s[20:23], s3 offen
    s_add_u32 s3, s34, 1198080
    buffer_load_dword v31, v3, s[16:19], s3 offen
    buffer_load_dword v39, v3, s[20:23], s3 offen
    s_add_u32 s3, s34, 1207296
    buffer_load_dword v35, v3, s[16:19], s3 offen
    buffer_load_dword v43, v3, s[20:23], s3 offen
    s_add_u32 s3, s34, 1216512
    buffer_load_dword v32, v3, s[16:19], s3 offen
    buffer_load_dword v40, v3, s[20:23], s3 offen
    s_add_u32 s3, s34, 1225728
    buffer_load_dword v36, v3, s[16:19], s3 offen
    buffer_load_dword v44, v3, s[20:23], s3 offen
    s_add_u32 s3, s34, 1234944
    buffer_load_dword v33, v3, s[16:19], s3 offen
    buffer_load_dword v41, v3, s[20:23], s3 offen
    s_add_u32 s3, s34, 1244160
    buffer_load_dword v37, v3, s[16:19], s3 offen
    buffer_load_dword v45, v3, s[20:23], s3 offen
    s_add_u32 s3, s34, 2359296
    buffer_load_dword v46, v3, s[16:19], s3 offen
    buffer_load_dword v54, v3, s[20:23], s3 offen
    s_add_u32 s3, s34, 2368512
    buffer_load_dword v50, v3, s[16:19], s3 offen
    buffer_load_dword v58, v3, s[20:23], s3 offen
    s_add_u32 s3, s34, 2377728
    buffer_load_dword v47, v3, s[16:19], s3 offen
    buffer_load_dword v55, v3, s[20:23], s3 offen
    s_add_u32 s3, s34, 2386944
    buffer_load_dword v51, v3, s[16:19], s3 offen
    buffer_load_dword v59, v3, s[20:23], s3 offen
    s_add_u32 s3, s34, 2396160
    buffer_load_dword v48, v3, s[16:19], s3 offen
    buffer_load_dword v56, v3, s[20:23], s3 offen
    s_add_u32 s3, s34, 2405376
    buffer_load_dword v52, v3, s[16:19], s3 offen
    buffer_load_dword v60, v3, s[20:23], s3 offen
    s_add_u32 s3, s34, 2414592
    buffer_load_dword v49, v3, s[16:19], s3 offen
    buffer_load_dword v57, v3, s[20:23], s3 offen
    s_add_u32 s3, s34, 2423808
    buffer_load_dword v53, v3, s[16:19], s3 offen
    buffer_load_dword v61, v3, s[20:23], s3 offen
    s_add_u32 s3, s34, 3538944
    buffer_load_dword v62, v3, s[16:19], s3 offen
    buffer_load_dword v70, v3, s[20:23], s3 offen
    s_add_u32 s3, s34, 3548160
    buffer_load_dword v66, v3, s[16:19], s3 offen
    buffer_load_dword v74, v3, s[20:23], s3 offen
    s_add_u32 s3, s34, 3557376
    buffer_load_dword v63, v3, s[16:19], s3 offen
    buffer_load_dword v71, v3, s[20:23], s3 offen
    s_add_u32 s3, s34, 3566592
    buffer_load_dword v67, v3, s[16:19], s3 offen
    buffer_load_dword v75, v3, s[20:23], s3 offen
    s_add_u32 s3, s34, 3575808
    buffer_load_dword v64, v3, s[16:19], s3 offen
    buffer_load_dword v72, v3, s[20:23], s3 offen
    s_add_u32 s3, s34, 3585024
    buffer_load_dword v68, v3, s[16:19], s3 offen
    buffer_load_dword v76, v3, s[20:23], s3 offen
    s_add_u32 s3, s34, 3594240
    buffer_load_dword v65, v3, s[16:19], s3 offen
    buffer_load_dword v73, v3, s[20:23], s3 offen
    s_add_u32 s3, s34, 3603456
    buffer_load_dword v69, v3, s[16:19], s3 offen
    buffer_load_dword v77, v3, s[20:23], s3 offen
    s_add_u32 s3, s34, 4718592
    buffer_load_dword v78, v5, s[16:19], s3 offen
    buffer_load_dword v86, v5, s[20:23], s3 offen
    s_add_u32 s3, s34, 4727808
    buffer_load_dword v82, v5, s[16:19], s3 offen
    buffer_load_dword v90, v5, s[20:23], s3 offen
    s_add_u32 s3, s34, 4737024
    buffer_load_dword v79, v5, s[16:19], s3 offen
    buffer_load_dword v87, v5, s[20:23], s3 offen
    s_add_u32 s3, s34, 4746240
    buffer_load_dword v83, v5, s[16:19], s3 offen
    buffer_load_dword v91, v5, s[20:23], s3 offen
    s_add_u32 s3, s34, 4755456
    buffer_load_dword v80, v5, s[16:19], s3 offen
    buffer_load_dword v88, v5, s[20:23], s3 offen
    s_add_u32 s3, s34, 4764672
    buffer_load_dword v84, v5, s[16:19], s3 offen
    buffer_load_dword v92, v5, s[20:23], s3 offen
    s_add_u32 s3, s34, 4773888
    buffer_load_dword v81, v5, s[16:19], s3 offen
    buffer_load_dword v89, v5, s[20:23], s3 offen
    s_add_u32 s3, s34, 4783104
    buffer_load_dword v85, v5, s[16:19], s3 offen
    buffer_load_dword v93, v5, s[20:23], s3 offen
    buffer_load_dwordx4 v[94:97], v4, s[24:27], s63 offen offset:0
    buffer_load_ushort v126, v6, s[24:27], s63 offen offset:0
    buffer_load_dwordx4 v[98:101], v4, s[24:27], s63 offen offset:1152
    buffer_load_ushort v127, v6, s[24:27], s63 offen offset:1152
    buffer_load_dwordx4 v[102:105], v4, s[24:27], s63 offen offset:2304
    buffer_load_ushort v128, v6, s[24:27], s63 offen offset:2304
    buffer_load_dwordx4 v[106:109], v4, s[24:27], s63 offen offset:3456
    buffer_load_ushort v129, v6, s[24:27], s63 offen offset:3456
    buffer_load_dwordx4 v[110:113], v4, s[24:27], s35 offen offset:0
    buffer_load_ushort v130, v6, s[24:27], s35 offen offset:0
    buffer_load_dwordx4 v[114:117], v4, s[24:27], s35 offen offset:1152
    buffer_load_ushort v131, v6, s[24:27], s35 offen offset:1152
    buffer_load_dwordx4 v[118:121], v4, s[24:27], s35 offen offset:2304
    buffer_load_ushort v132, v6, s[24:27], s35 offen offset:2304
    buffer_load_dwordx4 v[122:125], v4, s[24:27], s35 offen offset:3456
    buffer_load_ushort v133, v6, s[24:27], s35 offen offset:3456
    s_waitcnt vmcnt(63)
    v_perm_b32 v10, v18, v14, s32
    v_perm_b32 v18, v18, v14, s33
    v_perm_b32 v11, v19, v15, s32
    v_perm_b32 v19, v19, v15, s33
    v_perm_b32 v12, v20, v16, s32
    v_perm_b32 v20, v20, v16, s33
    v_perm_b32 v13, v21, v17, s32
    v_perm_b32 v21, v21, v17, s33
    v_perm_b32 v14, v26, v22, s32
    v_perm_b32 v26, v26, v22, s33
    v_perm_b32 v15, v27, v23, s32
    v_perm_b32 v27, v27, v23, s33
    v_perm_b32 v16, v28, v24, s32
    v_perm_b32 v28, v28, v24, s33
    v_perm_b32 v17, v29, v25, s32
    v_perm_b32 v29, v29, v25, s33
    s_waitcnt vmcnt(63)
    v_perm_b32 v22, v34, v30, s32
    v_perm_b32 v34, v34, v30, s33
    v_perm_b32 v23, v35, v31, s32
    v_perm_b32 v35, v35, v31, s33
    v_perm_b32 v24, v36, v32, s32
    v_perm_b32 v36, v36, v32, s33
    v_perm_b32 v25, v37, v33, s32
    v_perm_b32 v37, v37, v33, s33
    v_perm_b32 v30, v42, v38, s32
    v_perm_b32 v42, v42, v38, s33
    v_perm_b32 v31, v43, v39, s32
    v_perm_b32 v43, v43, v39, s33
    v_perm_b32 v32, v44, v40, s32
    v_perm_b32 v44, v44, v40, s33
    v_perm_b32 v33, v45, v41, s32
    v_perm_b32 v45, v45, v41, s33
    s_waitcnt vmcnt(48)
    v_perm_b32 v38, v50, v46, s32
    v_perm_b32 v50, v50, v46, s33
    v_perm_b32 v39, v51, v47, s32
    v_perm_b32 v51, v51, v47, s33
    v_perm_b32 v40, v52, v48, s32
    v_perm_b32 v52, v52, v48, s33
    v_perm_b32 v41, v53, v49, s32
    v_perm_b32 v53, v53, v49, s33
    v_perm_b32 v46, v58, v54, s32
    v_perm_b32 v58, v58, v54, s33
    v_perm_b32 v47, v59, v55, s32
    v_perm_b32 v59, v59, v55, s33
    v_perm_b32 v48, v60, v56, s32
    v_perm_b32 v60, v60, v56, s33
    v_perm_b32 v49, v61, v57, s32
    v_perm_b32 v61, v61, v57, s33
    s_waitcnt vmcnt(32)
    v_perm_b32 v54, v66, v62, s32
    v_perm_b32 v66, v66, v62, s33
    v_perm_b32 v55, v67, v63, s32
    v_perm_b32 v67, v67, v63, s33
    v_perm_b32 v56, v68, v64, s32
    v_perm_b32 v68, v68, v64, s33
    v_perm_b32 v57, v69, v65, s32
    v_perm_b32 v69, v69, v65, s33
    v_perm_b32 v62, v74, v70, s32
    v_perm_b32 v74, v74, v70, s33
    v_perm_b32 v63, v75, v71, s32
    v_perm_b32 v75, v75, v71, s33
    v_perm_b32 v64, v76, v72, s32
    v_perm_b32 v76, v76, v72, s33
    v_perm_b32 v65, v77, v73, s32
    v_perm_b32 v77, v77, v73, s33
    s_waitcnt vmcnt(16)
    v_perm_b32 v70, v82, v78, s32
    v_perm_b32 v82, v82, v78, s33
    v_perm_b32 v71, v83, v79, s32
    v_perm_b32 v83, v83, v79, s33
    v_perm_b32 v72, v84, v80, s32
    v_perm_b32 v84, v84, v80, s33
    v_perm_b32 v73, v85, v81, s32
    v_perm_b32 v85, v85, v81, s33
    v_perm_b32 v78, v90, v86, s32
    v_perm_b32 v90, v90, v86, s33
    v_perm_b32 v79, v91, v87, s32
    v_perm_b32 v91, v91, v87, s33
    v_perm_b32 v80, v92, v88, s32
    v_perm_b32 v92, v92, v88, s33
    v_perm_b32 v81, v93, v89, s32
    v_perm_b32 v93, v93, v89, s33
    s_waitcnt vmcnt(0)
    v_perm_b32 v134, v98, v94, s32
    v_perm_b32 v135, v106, v102, s32
    v_perm_b32 v136, v114, v110, s32
    v_perm_b32 v137, v122, v118, s32
    v_perm_b32 v138, v98, v94, s33
    v_perm_b32 v139, v106, v102, s33
    v_perm_b32 v140, v114, v110, s33
    v_perm_b32 v141, v122, v118, s33
    v_perm_b32 v142, v99, v95, s32
    v_perm_b32 v143, v107, v103, s32
    v_perm_b32 v144, v115, v111, s32
    v_perm_b32 v145, v123, v119, s32
    v_perm_b32 v146, v99, v95, s33
    v_perm_b32 v147, v107, v103, s33
    v_perm_b32 v148, v115, v111, s33
    v_perm_b32 v149, v123, v119, s33
    v_perm_b32 v150, v100, v96, s32
    v_perm_b32 v151, v108, v104, s32
    v_perm_b32 v152, v116, v112, s32
    v_perm_b32 v153, v124, v120, s32
    v_perm_b32 v154, v100, v96, s33
    v_perm_b32 v155, v108, v104, s33
    v_perm_b32 v156, v116, v112, s33
    v_perm_b32 v157, v124, v120, s33
    v_perm_b32 v158, v101, v97, s32
    v_perm_b32 v159, v109, v105, s32
    v_perm_b32 v160, v117, v113, s32
    v_perm_b32 v161, v125, v121, s32
    v_perm_b32 v162, v101, v97, s33
    v_perm_b32 v163, v109, v105, s33
    v_perm_b32 v164, v117, v113, s33
    v_perm_b32 v165, v125, v121, s33
    v_lshl_or_b32 v166, v127, 16, v126
    v_lshl_or_b32 v167, v129, 16, v128
    v_lshl_or_b32 v168, v131, 16, v130
    v_lshl_or_b32 v169, v133, 16, v132
    v_and_b32 v1, 1, v7
    v_bfe_u32 v2, v7, 1, 2
    v_lshl_add_u32 v1, v1, 2, v2
    s_lshl_b32 s3, s61, 3
    s_cmp_ge_u32 s61, 72
    s_cselect_b32 s34, 576, 0
    s_cselect_b32 s35, 1536, 0
    s_cselect_b32 s63, 1, 0
    s_sub_u32 s3, s3, s34
    v_add_u32 v1, s3, v1
    v_and_b32 v2, 0x180, v1
    v_bfe_u32 v3, v1, 4, 3
    v_add_u32 v2, v2, v3
    v_and_b32 v3, 15, v1
    v_lshl_add_u32 v2, v3, 3, v2
    v_cmp_lt_u32 vcc, 0x1ff, v1
    s_nop 1
    v_cndmask_b32 v2, v2, v1, vcc
    v_lshlrev_b32 v2, 1, v2
    v_add_u32 v1, s35, v2
    s_cmp_lg_u32 s62, 0
    s_cbranch_scc1 MOE_WAIT
    v_lshlrev_b32 v3, 4, v7
    s_movk_i32 s3, 0x1000
    v_mov_b32 v208, 0
    s_mul_i32 s56, s61, 48
MOE_P1:
    buffer_load_dword v202, v208, s[36:39], s56 offen sc1
    s_waitcnt vmcnt(0)
    v_cmp_eq_u32 vcc, 0, v202
    s_cbranch_vccz MOE_POLL
    s_sleep 6
    s_branch MOE_P1
MOE_POLL:
    buffer_load_dwordx4 v[170:173], v3, s[36:39], 0 offen offset:0 sc1
    buffer_load_dwordx4 v[174:177], v3, s[36:39], 0 offen offset:1024 sc1
    buffer_load_dwordx4 v[178:181], v3, s[36:39], 0 offen offset:2048 sc1
    buffer_load_dwordx4 v[182:185], v3, s[36:39], 0 offen offset:3072 sc1
    buffer_load_dwordx4 v[186:189], v3, s[36:39], s3 offen offset:0 sc1
    buffer_load_dwordx4 v[190:193], v3, s[36:39], s3 offen offset:1024 sc1
    buffer_load_dwordx4 v[194:197], v3, s[36:39], s3 offen offset:2048 sc1
    buffer_load_dwordx4 v[198:201], v3, s[36:39], s3 offen offset:3072 sc1
    s_waitcnt vmcnt(0)
    v_min3_u32 v202, v170, v171, v172
    v_min3_u32 v202, v202, v173, v174
    v_min3_u32 v202, v202, v175, v176
    v_min3_u32 v202, v202, v177, v178
    v_min3_u32 v202, v202, v179, v180
    v_min3_u32 v202, v202, v181, v182
    v_min3_u32 v202, v202, v183, v184
    v_min3_u32 v202, v202, v185, v186
    v_min3_u32 v202, v202, v187, v188
    v_min3_u32 v202, v202, v189, v190
    v_min3_u32 v202, v202, v191, v192
    v_min3_u32 v202, v202, v193, v194
    v_min3_u32 v202, v202, v195, v196
    v_min3_u32 v202, v202, v197, v198
    v_min3_u32 v202, v202, v199, v200
    v_min_u32 v202, v202, v201
    v_cmp_eq_u32 vcc, 0, v202
    s_cbranch_vccz MOE_GO
    s_sleep 8
    s_branch MOE_POLL
MOE_GO:
    v_max_u32 v204, v170, v171
    v_min_u32 v205, v170, v171
    v_med3_u32 v205, v204, v205, v172
    v_max_u32 v204, v204, v172
    v_med3_u32 v205, v204, v205, v173
    v_max_u32 v204, v204, v173
    v_med3_u32 v205, v204, v205, v174
    v_max_u32 v204, v204, v174
    v_med3_u32 v205, v204, v205, v175
    v_max_u32 v204, v204, v175
    v_med3_u32 v205, v204, v205, v176
    v_max_u32 v204, v204, v176
    v_med3_u32 v205, v204, v205, v177
    v_max_u32 v204, v204, v177
    v_med3_u32 v205, v204, v205, v178
    v_max_u32 v204, v204, v178
    v_med3_u32 v205, v204, v205, v179
    v_max_u32 v204, v204, v179
    v_med3_u32 v205, v204, v205, v180
    v_max_u32 v204, v204, v180
    v_med3_u32 v205, v204, v205, v181
    v_max_u32 v204, v204, v181
    v_med3_u32 v205, v204, v205, v182
    v_max_u32 v204, v204, v182
    v_med3_u32 v205, v204, v205, v183
    v_max_u32 v204, v204, v183
    v_med3_u32 v205, v204, v205, v184
    v_max_u32 v204, v204, v184
    v_med3_u32 v205, v204, v205, v185
    v_max_u32 v204, v204, v185
    v_med3_u32 v205, v204, v205, v186
    v_max_u32 v204, v204, v186
    v_med3_u32 v205, v204, v205, v187
    v_max_u32 v204, v204, v187
    v_med3_u32 v205, v204, v205, v188
    v_max_u32 v204, v204, v188
    v_med3_u32 v205, v204, v205, v189
    v_max_u32 v204, v204, v189
    v_med3_u32 v205, v204, v205, v190
    v_max_u32 v204, v204, v190
    v_med3_u32 v205, v204, v205, v191
    v_max_u32 v204, v204, v191
    v_med3_u32 v205, v204, v205, v192
    v_max_u32 v204, v204, v192
    v_med3_u32 v205, v204, v205, v193
    v_max_u32 v204, v204, v193
    v_med3_u32 v205, v204, v205, v194
    v_max_u32 v204, v204, v194
    v_med3_u32 v205, v204, v205, v195
    v_max_u32 v204, v204, v195
    v_med3_u32 v205, v204, v205, v196
    v_max_u32 v204, v204, v196
    v_med3_u32 v205, v204, v205, v197
    v_max_u32 v204, v204, v197
    v_med3_u32 v205, v204, v205, v198
    v_max_u32 v204, v204, v198
    v_med3_u32 v205, v204, v205, v199
    v_max_u32 v204, v204, v199
    v_med3_u32 v205, v204, v205, v200
    v_max_u32 v204, v204, v200
    v_med3_u32 v205, v204, v205, v201
    v_max_u32 v204, v204, v201
    v_mov_b32 v206, v204
    s_nop 1
    v_max_u32_dpp v206, v206, v206 quad_perm:[1,0,3,2] row_mask:0xf bank_mask:0xf
    s_nop 1
    v_max_u32_dpp v206, v206, v206 quad_perm:[2,3,0,1] row_mask:0xf bank_mask:0xf
    s_nop 1
    v_max_u32_dpp v206, v206, v206 row_half_mirror row_mask:0xf bank_mask:0xf
    s_nop 1
    v_max_u32_dpp v206, v206, v206 row_mirror row_mask:0xf bank_mask:0xf
    ds_swizzle_b32 v207, v206 offset:0x401F
    s_waitcnt lgkmcnt(0)
    v_max_u32 v206, v206, v207
    s_nop 1
    v_readlane_b32 s52, v206, 0
    v_readlane_b32 s54, v206, 32
    s_nop 3
    s_max_u32 s52, s52, s54
    v_cmp_eq_u32 vcc, s52, v204
    s_nop 1
    v_cndmask_b32 v206, v204, v205, vcc
    s_nop 1
    v_max_u32_dpp v206, v206, v206 quad_perm:[1,0,3,2] row_mask:0xf bank_mask:0xf
    s_nop 1
    v_max_u32_dpp v206, v206, v206 quad_perm:[2,3,0,1] row_mask:0xf bank_mask:0xf
    s_nop 1
    v_max_u32_dpp v206, v206, v206 row_half_mirror row_mask:0xf bank_mask:0xf
    s_nop 1
    v_max_u32_dpp v206, v206, v206 row_mirror row_mask:0xf bank_mask:0xf
    ds_swizzle_b32 v207, v206 offset:0x401F
    s_waitcnt lgkmcnt(0)
    v_max_u32 v206, v206, v207
    s_nop 1
    v_readlane_b32 s53, v206, 0
    v_readlane_b32 s54, v206, 32
    s_nop 3
    s_max_u32 s53, s53, s54
    s_andn2_b32 s56, 0xffff, s52
    s_andn2_b32 s57, 0xffff, s53
    s_lshl_b32 s56, s56, 3
    s_lshl_b32 s57, s57, 3
    v_mov_b32 v206, s52
    v_mov_b32 v207, s53
    ds_write_b64 v208, v[206:207] offset:4096
MOE_P2:
    buffer_load_dwordx2 v[210:211], v208, s[48:51], s56 offen sc1
    buffer_load_dwordx2 v[212:213], v208, s[48:51], s57 offen sc1
    s_waitcnt vmcnt(0)
    v_and_b32 v214, v210, v212
    v_and_b32 v214, 1, v214
    v_and_b32 v210, 0xffff0000, v210
    v_and_b32 v212, 0xffff0000, v212
    v_cmp_eq_u32 vcc, 0, v214
    s_cbranch_vccz MOE_G2
    s_sleep 4
    s_branch MOE_P2
MOE_G2:
    ds_write_b128 v208, v[210:213] offset:4112
    s_waitcnt lgkmcnt(0)
MOE_WAIT:
    s_barrier
    v_mov_b32 v208, 0
    ds_read_b64 v[206:207], v208 offset:4096
    ds_read_b128 v[210:213], v208 offset:4112
    v_lshlrev_b32 v209, 1, v0
    s_waitcnt lgkmcnt(0)
    v_readfirstlane_b32 s52, v206
    v_readfirstlane_b32 s53, v207
    s_nop 3
    s_and_b32 s54, s52, 0xffff
    s_sub_u32 s54, 0xffff, s54
    s_and_b32 s55, s53, 0xffff
    s_sub_u32 s55, 0xffff, s55
    s_mul_i32 s54, s54, 1152
    s_mul_i32 s55, s55, 1152
    v_mov_b32 v3, 0x7fff0000
    v_cmp_lt_u32 vcc, 63, v0
    s_nop 1
    v_cndmask_b32 v3, v209, v3, vcc
    buffer_load_ushort v214, v209, s[40:43], s54 offen offset:0 sc1
    buffer_load_ushort v215, v209, s[40:43], s55 offen offset:0 sc1
    buffer_load_ushort v216, v209, s[40:43], s54 offen offset:512 sc1
    buffer_load_ushort v217, v209, s[40:43], s55 offen offset:512 sc1
    buffer_load_ushort v218, v3, s[40:43], s54 offen offset:1024 sc1
    buffer_load_ushort v219, v3, s[40:43], s55 offen offset:1024 sc1
    v_and_b32 v3, 1, v8
    v_mul_u32_u24 v5, 1536, v3
    v_lshl_add_u32 v5, v9, 4, v5
    s_lshl_b32 s3, s62, 6
    v_add_u32 v5, s3, v5
    v_lshlrev_b32 v3, 6, v3
    v_lshl_add_u32 v3, v9, 4, v3
    s_lshl_b32 s3, s62, 7
    v_add_u32 v3, s3, v3
    v_lshl_add_u32 v4, v7, 1, s3
    s_lshl_b32 s3, s62, 9
    s_add_u32 s3, s3, 0x1000
    v_lshl_add_u32 v6, v8, 3, s3
    v_lshrrev_b32 v94, 5, v7
    v_and_b32 v95, 31, v7
    v_lshlrev_b32 v94, 8, v94
    v_lshl_add_u32 v94, v95, 2, v94
    v_add_u32 v94, 0x1000, v94
    v_add_u32 v95, 0x400, v94
    s_cmp_lg_u32 s63, 0
    s_cselect_b32 s52, s53, s52
    s_cselect_b32 s54, s55, s54
    s_waitcnt vmcnt(0)
    ds_write_b16 v209, v214 offset:12288
    ds_write_b16 v209, v215 offset:13824
    v_lshlrev_b32 v220, 16, v214
    v_lshlrev_b32 v221, 16, v215
    v_sub_f32 v220, v220, v210
    v_sub_f32 v221, v221, v212
    v_cvt_pk_bf16_f32 v221, v220, v221
    v_lshlrev_b32 v220, 16, v221
    v_and_b32 v221, 0xffff0000, v221
    v_mul_f32 v220, v220, v211
    v_mul_f32 v221, v221, v213
    v_cvt_pk_bf16_f32 v220, v220, v221
    ds_write_b16 v209, v220 offset:0
    ds_write_b16_d16_hi v209, v220 offset:1536
    ds_write_b16 v209, v216 offset:12800
    ds_write_b16 v209, v217 offset:14336
    v_lshlrev_b32 v222, 16, v216
    v_lshlrev_b32 v223, 16, v217
    v_sub_f32 v222, v222, v210
    v_sub_f32 v223, v223, v212
    v_cvt_pk_bf16_f32 v223, v222, v223
    v_lshlrev_b32 v222, 16, v223
    v_and_b32 v223, 0xffff0000, v223
    v_mul_f32 v222, v222, v211
    v_mul_f32 v223, v223, v213
    v_cvt_pk_bf16_f32 v222, v222, v223
    ds_write_b16 v209, v222 offset:512
    ds_write_b16_d16_hi v209, v222 offset:2048
    ds_write_b16 v209, v218 offset:13312
    ds_write_b16 v209, v219 offset:14848
    v_lshlrev_b32 v224, 16, v218
    v_lshlrev_b32 v225, 16, v219
    v_sub_f32 v224, v224, v210
    v_sub_f32 v225, v225, v212
    v_cvt_pk_bf16_f32 v225, v224, v225
    v_lshlrev_b32 v224, 16, v225
    v_and_b32 v225, 0xffff0000, v225
    v_mul_f32 v224, v224, v211
    v_mul_f32 v225, v225, v213
    v_cvt_pk_bf16_f32 v224, v224, v225
    ds_write_b16 v209, v224 offset:1024
    ds_write_b16_d16_hi v209, v224 offset:2560
    s_waitcnt lgkmcnt(0)
    s_barrier
    ds_read_b128 v[170:173], v5 offset:0
    ds_read_b128 v[174:177], v5 offset:256
    ds_read_b128 v[178:181], v5 offset:512
    ds_read_b128 v[182:185], v5 offset:768
    ds_read_b128 v[186:189], v5 offset:1024
    ds_read_u16 v96, v1 offset:12288
    ds_read_u16 v97, v1
    s_waitcnt lgkmcnt(6)
    v_mfma_f32_16x16x32_bf16 v[190:193], v[170:173], v[10:13], 0
    v_mfma_f32_16x16x32_bf16 v[194:197], v[170:173], v[18:21], 0
    v_mfma_f32_16x16x32_bf16 v[198:201], v[170:173], v[14:17], 0
    v_mfma_f32_16x16x32_bf16 v[202:205], v[170:173], v[26:29], 0
    s_waitcnt lgkmcnt(5)
    v_mfma_f32_16x16x32_bf16 v[190:193], v[174:177], v[22:25], v[190:193]
    v_mfma_f32_16x16x32_bf16 v[194:197], v[174:177], v[34:37], v[194:197]
    v_mfma_f32_16x16x32_bf16 v[198:201], v[174:177], v[30:33], v[198:201]
    v_mfma_f32_16x16x32_bf16 v[202:205], v[174:177], v[42:45], v[202:205]
    s_waitcnt lgkmcnt(4)
    v_mfma_f32_16x16x32_bf16 v[190:193], v[178:181], v[38:41], v[190:193]
    v_mfma_f32_16x16x32_bf16 v[194:197], v[178:181], v[50:53], v[194:197]
    v_mfma_f32_16x16x32_bf16 v[198:201], v[178:181], v[46:49], v[198:201]
    v_mfma_f32_16x16x32_bf16 v[202:205], v[178:181], v[58:61], v[202:205]
    s_waitcnt lgkmcnt(3)
    v_mfma_f32_16x16x32_bf16 v[190:193], v[182:185], v[54:57], v[190:193]
    v_mfma_f32_16x16x32_bf16 v[194:197], v[182:185], v[66:69], v[194:197]
    v_mfma_f32_16x16x32_bf16 v[198:201], v[182:185], v[62:65], v[198:201]
    v_mfma_f32_16x16x32_bf16 v[202:205], v[182:185], v[74:77], v[202:205]
    s_waitcnt lgkmcnt(2)
    v_mfma_f32_16x16x32_bf16 v[190:193], v[186:189], v[70:73], v[190:193]
    v_mfma_f32_16x16x32_bf16 v[194:197], v[186:189], v[82:85], v[194:197]
    v_mfma_f32_16x16x32_bf16 v[198:201], v[186:189], v[78:81], v[198:201]
    v_mfma_f32_16x16x32_bf16 v[202:205], v[186:189], v[90:93], v[202:205]
    s_and_b32 s3, s52, 0xffff0000
    s_ashr_i32 s56, s3, 31
    s_not_b32 s56, s56
    s_or_b32 s56, s56, 0x80000000
    s_xor_b32 s3, s3, s56
    s_and_b32 s3, s3, 0xffff0000
    v_mov_b32 v98, s3
    v_mul_f32 v98, 0xbfb8aa3b, v98
    v_exp_f32 v98, v98
    s_nop 0
    v_add_f32 v98, 1.0, v98
    v_rcp_f32 v98, v98
    s_nop 0
    v_cvt_pk_bf16_f32 v98, v98, v98
    v_lshlrev_b32 v98, 16, v98
    ds_write2_b32 v6, v190, v194 offset0:0 offset1:1
    ds_write2_b32 v6, v191, v195 offset0:64 offset1:65
    ds_write2_b32 v6, v198, v202 offset0:32 offset1:33
    ds_write2_b32 v6, v199, v203 offset0:96 offset1:97
    s_waitcnt lgkmcnt(0)
    s_barrier
    ds_read2_b32 v[100:101], v94 offset0:0 offset1:32
    ds_read2_b32 v[102:103], v94 offset0:128 offset1:160
    ds_read2_b32 v[104:105], v95 offset0:0 offset1:32
    ds_read2_b32 v[106:107], v95 offset0:128 offset1:160
    v_lshrrev_b32 v6, 3, v8
    v_mul_u32_u24 v6, 4608, v6
    v_and_b32 v5, 7, v8
    v_lshl_add_u32 v6, v5, 2, v6
    s_lshl_b32 s3, s61, 5
    s_mul_i32 s56, s62, 73728
    s_add_u32 s56, s56, s3
    s_mul_i32 s57, s62, 9216
    s_add_u32 s57, s57, s3
    s_waitcnt lgkmcnt(0)
    v_add_f32 v100, v100, v102
    v_add_f32 v101, v101, v103
    v_add_f32 v104, v104, v106
    v_add_f32 v105, v105, v107
    v_add_f32 v100, v100, v104
    v_add_f32 v101, v101, v105
    v_cvt_pk_bf16_f32 v101, v100, v101
    v_lshlrev_b32 v100, 16, v101
    v_and_b32 v101, 0xffff0000, v101
    v_mul_f32 v102, 0xbfb8aa3b, v100
    v_exp_f32 v102, v102
    s_nop 0
    v_add_f32 v102, 1.0, v102
    v_rcp_f32 v102, v102
    s_nop 0
    v_mul_f32 v102, v102, v100
    v_cvt_pk_bf16_f32 v102, v102, v102
    v_lshlrev_b32 v102, 16, v102
    v_mul_f32 v102, v102, v101
    v_cvt_pk_bf16_f32 v102, v102, v102
    ds_write_b16 v4, v102 offset:8192
    s_waitcnt lgkmcnt(0)
    ds_read_b128 v[100:103], v3 offset:8192
    s_waitcnt lgkmcnt(0)
    v_mfma_f32_16x16x32_bf16 v[10:13], v[100:103], v[134:137], 0
    v_mfma_f32_16x16x32_bf16 v[14:17], v[100:103], v[138:141], 0
    v_mfma_f32_16x16x32_bf16 v[18:21], v[100:103], v[142:145], 0
    v_mfma_f32_16x16x32_bf16 v[22:25], v[100:103], v[146:149], 0
    v_mfma_f32_16x16x32_bf16 v[26:29], v[100:103], v[150:153], 0
    v_mfma_f32_16x16x32_bf16 v[30:33], v[100:103], v[154:157], 0
    v_mfma_f32_16x16x32_bf16 v[34:37], v[100:103], v[158:161], 0
    v_mfma_f32_16x16x32_bf16 v[38:41], v[100:103], v[162:165], 0
    v_mfma_f32_16x16x32_bf16 v[42:45], v[100:103], v[166:169], 0
    s_mov_b64 exec, 0xffff
    s_nop 4
    s_add_u32 s3, s56, 0
    v_min_u32 v10, -2, v10
    buffer_store_dword v10, v6, s[44:47], s3 offen sc1
    s_add_u32 s3, s56, 331776
    v_min_u32 v11, -2, v11
    buffer_store_dword v11, v6, s[44:47], s3 offen sc1
    s_add_u32 s3, s56, 9216
    v_min_u32 v14, -2, v14
    buffer_store_dword v14, v6, s[44:47], s3 offen sc1
    s_add_u32 s3, s56, 340992
    v_min_u32 v15, -2, v15
    buffer_store_dword v15, v6, s[44:47], s3 offen sc1
    s_add_u32 s3, s56, 18432
    v_min_u32 v18, -2, v18
    buffer_store_dword v18, v6, s[44:47], s3 offen sc1
    s_add_u32 s3, s56, 350208
    v_min_u32 v19, -2, v19
    buffer_store_dword v19, v6, s[44:47], s3 offen sc1
    s_add_u32 s3, s56, 27648
    v_min_u32 v22, -2, v22
    buffer_store_dword v22, v6, s[44:47], s3 offen sc1
    s_add_u32 s3, s56, 359424
    v_min_u32 v23, -2, v23
    buffer_store_dword v23, v6, s[44:47], s3 offen sc1
    s_add_u32 s3, s56, 36864
    v_min_u32 v26, -2, v26
    buffer_store_dword v26, v6, s[44:47], s3 offen sc1
    s_add_u32 s3, s56, 368640
    v_min_u32 v27, -2, v27
    buffer_store_dword v27, v6, s[44:47], s3 offen sc1
    s_add_u32 s3, s56, 46080
    v_min_u32 v30, -2, v30
    buffer_store_dword v30, v6, s[44:47], s3 offen sc1
    s_add_u32 s3, s56, 377856
    v_min_u32 v31, -2, v31
    buffer_store_dword v31, v6, s[44:47], s3 offen sc1
    s_add_u32 s3, s56, 55296
    v_min_u32 v34, -2, v34
    buffer_store_dword v34, v6, s[44:47], s3 offen sc1
    s_add_u32 s3, s56, 387072
    v_min_u32 v35, -2, v35
    buffer_store_dword v35, v6, s[44:47], s3 offen sc1
    s_add_u32 s3, s56, 64512
    v_min_u32 v38, -2, v38
    buffer_store_dword v38, v6, s[44:47], s3 offen sc1
    s_add_u32 s3, s56, 396288
    v_min_u32 v39, -2, v39
    buffer_store_dword v39, v6, s[44:47], s3 offen sc1
    s_add_u32 s3, s57, 294912
    v_min_u32 v42, -2, v42
    buffer_store_dword v42, v6, s[44:47], s3 offen sc1
    s_add_u32 s3, s57, 626688
    v_min_u32 v43, -2, v43
    buffer_store_dword v43, v6, s[44:47], s3 offen sc1
    s_mov_b64 exec, -1
    s_cmp_lg_u32 s62, 0
    s_cbranch_scc1 K4_FIN
    v_lshlrev_b32 v3, 4, v7
    v_add_u32 v4, 0x1000, v3
    v_mov_b32 v5, 0x7fff0000
    v_cmp_lt_u32 vcc, 31, v7
    s_mul_i32 s3, s61, 4608
    v_cndmask_b32 v4, v4, v5, vcc
    v_cmp_lt_u32 vcc, 7, v7
    v_lshlrev_b32 v96, 16, v96
    v_cndmask_b32 v2, v2, v5, vcc
    v_lshlrev_b32 v97, 16, v97
MOE_P3:
    buffer_load_dwordx4 v[46:49], v3, s[44:47], s3 offen offset:0 sc1
    buffer_load_dwordx4 v[50:53], v3, s[44:47], s3 offen offset:1024 sc1
    buffer_load_dwordx4 v[54:57], v3, s[44:47], s3 offen offset:2048 sc1
    buffer_load_dwordx4 v[58:61], v3, s[44:47], s3 offen offset:3072 sc1
    buffer_load_dwordx4 v[62:65], v4, s[44:47], s3 offen offset:0 sc1
    s_waitcnt vmcnt(0)
    v_max3_u32 v66, v46, v47, v48
    v_max3_u32 v66, v66, v49, v50
    v_max3_u32 v66, v66, v51, v52
    v_max3_u32 v66, v66, v53, v54
    v_max3_u32 v66, v66, v55, v56
    v_max3_u32 v66, v66, v57, v58
    v_max3_u32 v66, v66, v59, v60
    v_max3_u32 v66, v66, v61, v62
    v_max3_u32 v66, v66, v63, v64
    v_max_u32 v66, v66, v65
    v_cmp_eq_u32 vcc, -1, v66
    s_cbranch_vccz MOE_G3
    s_sleep 2
    s_branch MOE_P3
MOE_G3:
    v_add_f32 v46, v46, v50
    v_add_f32 v47, v47, v51
    v_add_f32 v48, v48, v52
    v_add_f32 v49, v49, v53
    v_add_f32 v46, v46, v54
    v_add_f32 v47, v47, v55
    v_add_f32 v48, v48, v56
    v_add_f32 v49, v49, v57
    v_add_f32 v46, v46, v58
    v_add_f32 v47, v47, v59
    v_add_f32 v48, v48, v60
    v_add_f32 v49, v49, v61
    v_add_f32 v46, v46, v62
    v_add_f32 v47, v47, v63
    v_add_f32 v48, v48, v64
    v_add_f32 v49, v49, v65
    s_nop 0
    v_add_f32_dpp v46, v46, v46 quad_perm:[2,3,0,1] row_mask:0xf bank_mask:0xf
    v_add_f32_dpp v47, v47, v47 quad_perm:[2,3,0,1] row_mask:0xf bank_mask:0xf
    v_add_f32_dpp v48, v48, v48 quad_perm:[2,3,0,1] row_mask:0xf bank_mask:0xf
    v_add_f32_dpp v49, v49, v49 quad_perm:[2,3,0,1] row_mask:0xf bank_mask:0xf
    s_nop 0
    v_add_f32_dpp v46, v46, v46 row_ror:4 row_mask:0xf bank_mask:0xf
    v_add_f32_dpp v47, v47, v47 row_ror:4 row_mask:0xf bank_mask:0xf
    v_add_f32_dpp v48, v48, v48 row_ror:4 row_mask:0xf bank_mask:0xf
    v_add_f32_dpp v49, v49, v49 row_ror:4 row_mask:0xf bank_mask:0xf
    s_nop 0
    v_add_f32_dpp v46, v46, v46 row_ror:8 row_mask:0xf bank_mask:0xf
    v_add_f32_dpp v47, v47, v47 row_ror:8 row_mask:0xf bank_mask:0xf
    v_add_f32_dpp v48, v48, v48 row_ror:8 row_mask:0xf bank_mask:0xf
    v_add_f32_dpp v49, v49, v49 row_ror:8 row_mask:0xf bank_mask:0xf
    v_and_b32 v5, 2, v7
    v_cmp_ne_u32 vcc, 0, v5
    v_and_b32 v5, 4, v7
    s_nop 0
    v_cndmask_b32 v46, v46, v47, vcc
    v_cndmask_b32 v48, v48, v49, vcc
    v_cmp_ne_u32 vcc, 0, v5
    v_xor_b32 v5, 32, v7
    v_lshlrev_b32 v5, 2, v5
    v_cndmask_b32 v46, v46, v48, vcc
    ds_swizzle_b32 v47, v46 offset:0x401F
    s_waitcnt lgkmcnt(0)
    v_add_f32 v46, v46, v47
    ds_bpermute_b32 v47, v5, v46
    s_waitcnt lgkmcnt(0)
    v_add_f32 v46, v46, v47
    v_cvt_pk_bf16_f32 v46, v46, v46
    v_lshlrev_b32 v46, 16, v46
    v_mul_f32 v46, v46, v98
    v_cvt_pk_bf16_f32 v46, v46, v46
    v_lshlrev_b32 v46, 16, v46
    v_add_f32 v46, v46, v97
    v_cvt_pk_bf16_f32 v46, v46, v46
    v_lshlrev_b32 v46, 16, v46
    v_add_f32 v46, v46, v96
    v_cvt_pk_bf16_f32 v46, v46, v46
    buffer_store_short v46, v2, s[28:31], s54 offen sc1
K4_FIN:
K4_END:
    s_endpgm
.section .rodata,"a"
.p2align 6
.amdhsa_kernel fa_kernel
  .amdhsa_next_free_vgpr 108
  .amdhsa_next_free_sgpr 64
  .amdhsa_accum_offset 108
  .amdhsa_group_segment_fixed_size 0
  .amdhsa_kernarg_size 88
  .amdhsa_user_sgpr_count 2
  .amdhsa_user_sgpr_kernarg_segment_ptr 1
  .amdhsa_system_sgpr_workgroup_id_x 1
.end_amdhsa_kernel
.p2align 6
.amdhsa_kernel fb_kernel
  .amdhsa_next_free_vgpr 188
  .amdhsa_next_free_sgpr 64
  .amdhsa_accum_offset 188
  .amdhsa_group_segment_fixed_size 0
  .amdhsa_kernarg_size 88
  .amdhsa_user_sgpr_count 2
  .amdhsa_user_sgpr_kernarg_segment_ptr 1
  .amdhsa_system_sgpr_workgroup_id_x 1
.end_amdhsa_kernel
.p2align 6
.amdhsa_kernel fc_kernel
  .amdhsa_next_free_vgpr 232
  .amdhsa_next_free_sgpr 64
  .amdhsa_accum_offset 232
  .amdhsa_group_segment_fixed_size 0
  .amdhsa_kernarg_size 88
  .amdhsa_user_sgpr_count 2
  .amdhsa_user_sgpr_kernarg_segment_ptr 1
  .amdhsa_system_sgpr_workgroup_id_x 1
.end_amdhsa_kernel
```
